```python
import torch

def _softmax(x, axis=-1):
    return torch.softmax(x, dim=axis)
def _gelu(x):
    return torch.nn.functional.gelu(x, approximate="tanh")
def _silu(x):
    return torch.nn.functional.silu(x)
def _sigmoid(x):
    return torch.sigmoid(x)
def _layernorm(x, axis=-1, eps=1e-5):
    m = x.mean(dim=axis, keepdim=True)
    v = x.var(dim=axis, keepdim=True, unbiased=False)
    return (x - m) / torch.sqrt(v + eps)
def _scatter_add(tgt, idx, src, axis=0):
    return tgt.clone().index_add_(axis, idx, src)
def _segment_sum(src, seg, n):
    out = torch.zeros((n,) + src.shape[1:], dtype=src.dtype)
    return out.index_add_(0, seg, src)
def _pad(x, pw):
    flat = tuple(v for pair in reversed(pw) for v in pair)
    return torch.nn.functional.pad(x, flat)

kernel_name = 'concat_heads__linear_kernel_hedgehog__ssm_conv_s4__prompt'

def setup_inputs():

    _w = (lambda a: (lambda t: t.to(torch.bfloat16) if t.is_floating_point() else t)(torch.as_tensor(a)))
    def _A_setup():
        B, S, D, H = 1, 2048, 640, 32
        Dh = D // H
        return {
            "x": _w((lambda *s: torch.randn(*s, dtype=torch.bfloat16) * 0.4)(B, S, D)),
            "wqkv": _w((lambda *s: torch.randn(*s, dtype=torch.bfloat16) * 0.4)(D, 3 * D)),
            "w_phi": _w((lambda *s: torch.randn(*s, dtype=torch.bfloat16) * 0.4)(H, Dh, Dh) * (Dh ** -0.5)),
            "wo": _w((lambda *s: torch.randn(*s, dtype=torch.bfloat16) * 0.05)(D, D)),
        }
    _A_in = _A_setup()

    def _B_setup():
        B, L, D, N = 1, 2048, 640, 128
        A_re = -(lambda _x: torch.exp(torch.as_tensor(_x)))((lambda *s: torch.randn(*s, dtype=torch.bfloat16) * 3.2)(D, N))
        A_im = torch.pi * (lambda *s: torch.randn(*s, dtype=torch.bfloat16) * 0.2)(D, N)
        B_re = (lambda *s: torch.randn(*s, dtype=torch.bfloat16) * 0.4)(D, N)
        B_im = (lambda *s: torch.randn(*s, dtype=torch.bfloat16) * 0.4)(D, N)
        C_re = (lambda *s: torch.randn(*s, dtype=torch.bfloat16) * 0.4)(D, N)
        C_im = (lambda *s: torch.randn(*s, dtype=torch.bfloat16) * 0.4)(D, N)
        log_dt = (lambda *s: torch.randn(*s, dtype=torch.bfloat16) * 0.2)(D) * 0.5 - 4.0
        Dskip = (lambda *s: torch.randn(*s, dtype=torch.bfloat16) * 0.4)(D)
        return {
            "u": _w((lambda *s: torch.randn(*s, dtype=torch.bfloat16) * 0.05)(B, L, D)),
            "A_re": _w(A_re),
            "A_im": _w(A_im),
            "B_re": _w(B_re),
            "B_im": _w(B_im),
            "C_re": _w(C_re),
            "C_im": _w(C_im),
            "log_dt": _w(log_dt),
            "Dskip": _w(Dskip),
        }
    _B_in = _B_setup()

    return {
        "A_x": _A_in["x"],
        "A_wqkv": _A_in["wqkv"],
        "A_w_phi": _A_in["w_phi"],
        "A_wo": _A_in["wo"],
        "B_u": _B_in["u"],
        "B_A_re": _B_in["A_re"],
        "B_A_im": _B_in["A_im"],
        "B_B_re": _B_in["B_re"],
        "B_B_im": _B_in["B_im"],
        "B_C_re": _B_in["C_re"],
        "B_C_im": _B_in["C_im"],
        "B_log_dt": _B_in["log_dt"],
        "B_Dskip": _B_in["Dskip"],
    }

def reference(A_x, A_wqkv, A_w_phi, A_wo, B_u, B_A_re, B_A_im, B_B_re, B_B_im, B_C_re, B_C_im, B_log_dt, B_Dskip):
    def _A_ref(x, wqkv, w_phi, wo):
        B, S, D = x.shape
        H = 32; Dh = D // H
        qkv = (lambda x, *d: x.permute(*d))((x @ wqkv).reshape(B, S, 3, H, Dh), 2, 0, 3, 1, 4)
        q, k, v = qkv[0], qkv[1], qkv[2]
        pq = torch.einsum("bhsd,hdf->bhsf", q, w_phi)
        pk = torch.einsum("bhsd,hdf->bhsf", k, w_phi)
        phi_q = torch.concatenate([_softmax(pq, axis=-1), _softmax(-pq, axis=-1)], axis=-1)
        phi_k = torch.concatenate([_softmax(pk, axis=-1), _softmax(-pk, axis=-1)], axis=-1)
        kv = torch.einsum("bhsf,bhsd->bhfd", phi_k, v)
        z  = torch.einsum("bhsf->bhf", phi_k)
        num = torch.einsum("bhqf,bhfd->bhqd", phi_q, kv)
        den = torch.einsum("bhqf,bhf->bhq", phi_q, z)[..., None] + 1e-6
        o = num / den
        return (lambda x, *d: x.permute(*d))(o, 0, 2, 1, 3).reshape(B, S, D) @ wo

    def _B_ref(u, A_re, A_im, B_re, B_im, C_re, C_im, log_dt, Dskip):
        Bsz, L, D = u.shape
        dt = torch.exp(log_dt)[:, None]
        A = A_re + 1j * A_im
        Bc = B_re + 1j * B_im
        Cc = C_re + 1j * C_im
        logdA = dt * A
        dB = dt * Bc
        l = (lambda x, dt: x.to(dt))(torch.arange(L), A_re.dtype)
        P = torch.exp(logdA[:, :, None] * l[None, None, :])
        K = torch.einsum("dn,dnl,dn->dl", Cc, P, dB).real
        L2 = 2 * L
        Kp = _pad(K, ((0, 0), (0, L)))
        up = (lambda x, *d: x.permute(*d))(u, 0, 2, 1)
        up = _pad(up, ((0, 0), (0, 0), (0, L)))
        Kf = (lambda x, axes=(-2,-1): torch.fft.rfft2(x.float(), dim=axes))(Kp[:, None, :], axes=(-2, -1))
        Uf = (lambda x, axes=(-2,-1): torch.fft.rfft2(x.float(), dim=axes))(up[:, :, None, :], axes=(-2, -1))
        Yf = Uf * Kf[None, :, :, :]
        y = (lambda x, s, axes=(-2,-1): torch.fft.irfft2(x, s=s, dim=axes).to(torch.bfloat16))(Yf, (1, L2), axes=(-2, -1))[:, :, 0, :L]
        y = (lambda x, *d: x.permute(*d))(y, 0, 2, 1) + u * Dskip[None, None, :]
        return y

    a = _A_ref(A_x, A_wqkv, A_w_phi, A_wo)
    b = _B_ref(B_u, B_A_re, B_A_im, B_B_re, B_B_im, B_C_re, B_C_im, B_log_dt, B_Dskip)
    return torch.concatenate([a, b], axis=-1)
```

```asm
; @launch grid=(496,1,1) block=(256,1,1) lds=81920
.amdgcn_target "amdgcn-amd-amdhsa--gfx950"
.text
.globl concat_heads__linear_kernel_hedgehog__ssm_conv_s4__prompt_kernel
.p2align 8
.type concat_heads__linear_kernel_hedgehog__ssm_conv_s4__prompt_kernel,@function
concat_heads__linear_kernel_hedgehog__ssm_conv_s4__prompt_kernel:
    s_load_dwordx16 s[16:31], s[0:1], 0
    s_load_dwordx16 s[32:47], s[0:1], 64
    s_memrealtime s[10:11]
    s_getpc_b64 s[12:13]
L_pc:
    s_lshl_b32 s3, s2, 7
    s_and_b32 s3, s3, 0x7c00
    v_lshrrev_b32_e64 v254, 5, v0
    v_lshl_add_u32 v254, v254, 7, s3
    v_min_u32 v254, L_code_end-L_pc-4, v254
    global_load_dword v255, v254, s[12:13]
    s_sub_u32 s77, s2, 256
    s_cmp_ge_u32 s77, 160
    s_cbranch_scc1 L_notB
    s_setprio 3
    s_lshl_b32 s4, s77, 10
    v_lshl_add_u32 v6, v0, 2, s4
    s_lshl_b32 s5, s77, 3
    s_waitcnt lgkmcnt(0)
    s_nop 0
    global_load_dword v136, v6, s[26:27]
    global_load_dword v137, v6, s[28:29]
    global_load_dword v138, v6, s[30:31]
    global_load_dword v139, v6, s[32:33]
    global_load_dword v140, v6, s[34:35]
    global_load_dword v141, v6, s[36:37]
    s_load_dwordx2 s[100:101], s[38:39], s5
    s_load_dwordx2 s[16:17], s[40:41], s5
    s_branch L_B
L_notB:
    s_cmp_ge_u32 s2, 256
    s_cbranch_scc1 L_notA
    s_setprio 2
    v_and_b32 v1, 63, v0
    v_lshrrev_b32 v200, 6, v0
    v_lshrrev_b32_e64 v208, 4, v1
    v_readfirstlane_b32 s76, v200
    s_and_b32 s4, s2, 7
    s_lshr_b32 s5, s2, 3
    s_lshr_b32 s81, s5, 2
    s_and_b32 s5, s5, 3
    s_lshl_b32 s80, s4, 2
    s_add_u32 s80, s80, s5
    s_lshr_b32 s77, s4, 1
    s_lshl_b32 s77, s77, 2
    s_add_u32 s77, s77, s5
    s_lshl_b32 s6, s81, 2
    s_lshr_b32 s6, 0x64317520, s6
    s_and_b32 s6, s6, 7
    s_and_b32 s78, s4, 1
    s_lshl_b32 s78, s78, 3
    s_add_u32 s78, s78, s6
    s_xor_b32 s79, s78, 1
    s_mul_i32 s82, s5, 3
    s_add_u32 s82, s82, s6
    s_sub_u32 s4, s82, 10
    s_cmp_ge_u32 s82, 10
    s_cselect_b32 s82, s4, s82
    s_mul_i32 s4, s79, 80
    s_mul_i32 s6, s78, 80
    s_sub_u32 s6, s6, s4
    v_lshlrev_b32 v200, 2, v208
    v_sub_u32 v200, v1, v200
    v_and_b32 v200, 15, v200
    v_min_u32 v200, 14, v200
    v_mul_u32_u24 v201, 52, v200
    v_lshrrev_b32_e64 v201, 8, v201
    v_mul_u32_u24 v202, 3840, v208
    v_lshl_add_u32 v202, v200, 4, v202
    v_min_u32_e64 v200, 1, v201
    v_mul_u32_u24 v201, 1200, v201
    v_mad_i32_i24 v202, v200, s6, v202
    v_add_u32_e64 v224, v201, v202
    v_add_u32 v225, 14336, v224
    v_add_u32 v226, 28672, v224
    v_add_u32 v227, 43008, v224
    v_lshrrev_b32 v200, 3, v1
    v_and_b32 v201, 7, v1
    v_xor_b32_e64 v201, v201, v208
    v_mul_u32_u24 v200, 1280, v200
    v_lshl_add_u32 v220, v201, 4, v200
    v_xor_b32_e64 v201, 4, v201
    v_lshl_add_u32 v221, v201, 4, v200
    v_add_u32 v222, 18432, v220
    v_add_u32 v223, 27648, v221
    v_add_u32 v221, 9216, v221
    s_mul_i32 s86, s76, 61440
    s_add_u32 s86, s86, s4
    s_mul_i32 s84, s82, 245760
    s_add_u32 s84, s84, s86
    s_add_u32 s86, s86, 2457600
    s_lshl_b32 s87, s77, 2
    s_add_u32 s87, s87, s76
    s_mul_i32 s87, s87, 40960
    s_lshl_b32 s85, s82, 7
    s_add_u32 s85, s85, s87
    s_add_u32 s87, s87, 1280
    s_lshl_b32 s88, s76, 12
    s_lshl_b32 s89, s76, 13
    s_add_u32 s89, s89, 49152
    s_waitcnt lgkmcnt(0)
    s_mov_b32 s64, s18
    s_and_b32 s65, s19, 0xffff
    s_mov_b32 s66, 2457600
    s_mov_b32 s67, 0x00020000
    s_mov_b32 s60, s16
    s_and_b32 s61, s17, 0xffff
    s_mov_b32 s62, 2621440
    s_mov_b32 s63, 0x00020000
    s_add_u32 m0, s88, 16384
    s_nop 0
    buffer_load_dwordx4 v224, s[64:67], s84 offen offset:0 lds
    buffer_load_dwordx4 v225, s[64:67], s84 offen offset:1024 lds
    buffer_load_dwordx4 v226, s[64:67], s84 offen offset:2048 lds
    buffer_load_dwordx4 v227, s[64:67], s84 offen offset:3072 lds
    s_add_u32 s84, s84, 245760
    s_cmp_ge_u32 s84, s86
    s_cselect_b32 s9, 2457600, 0
    s_sub_u32 s84, s84, s9
    s_add_u32 m0, s89, 0
    s_nop 0
    buffer_load_dwordx4 v220, s[60:63], s85 offen offset:0 lds
    buffer_load_dwordx4 v221, s[60:63], s85 offen offset:1024 lds
    buffer_load_dwordx4 v222, s[60:63], s85 offen offset:2048 lds
    buffer_load_dwordx4 v223, s[60:63], s85 offen offset:3072 lds
    s_add_u32 s85, s85, 128
    s_cmp_ge_u32 s85, s87
    s_cselect_b32 s9, 1280, 0
    s_sub_u32 s85, s85, s9
    s_mov_b32 s72, s20
    s_and_b32 s73, s21, 0xffff
    s_mov_b32 s74, 25600
    s_mov_b32 s75, 0x00020000
    v_lshlrev_b32 v198, 4, v0
    v_cmp_gt_u32 vcc, 200, v0
    v_mov_b32 v199, 0x100000
    s_lshr_b32 s4, s78, 1
    s_mul_i32 s4, s4, 3200
    v_cndmask_b32 v199, v199, v198, vcc
    buffer_load_dwordx4 v[180:183], v199, s[72:75], s4 offen
    s_add_u32 m0, s88, 32768
    s_nop 0
    s_nop 0
    buffer_load_dwordx4 v224, s[64:67], s84 offen offset:0 lds
    buffer_load_dwordx4 v225, s[64:67], s84 offen offset:1024 lds
    buffer_load_dwordx4 v226, s[64:67], s84 offen offset:2048 lds
    buffer_load_dwordx4 v227, s[64:67], s84 offen offset:3072 lds
    s_add_u32 s84, s84, 245760
    s_cmp_ge_u32 s84, s86
    s_cselect_b32 s9, 2457600, 0
    s_sub_u32 s84, s84, s9
    s_add_u32 m0, s89, 4096
    s_nop 0
    s_nop 0
    buffer_load_dwordx4 v220, s[60:63], s85 offen offset:0 lds
    buffer_load_dwordx4 v221, s[60:63], s85 offen offset:1024 lds
    buffer_load_dwordx4 v222, s[60:63], s85 offen offset:2048 lds
    buffer_load_dwordx4 v223, s[60:63], s85 offen offset:3072 lds
    s_add_u32 s85, s85, 128
    s_cmp_ge_u32 s85, s87
    s_cselect_b32 s9, 1280, 0
    s_sub_u32 s85, s85, s9
    s_mov_b32 s48, s46
    s_and_b32 s49, s47, 0xffff
    s_mov_b32 s50, 16777216
    s_mov_b32 s51, 0x00020000
    v_mov_b32 v212, -1
    v_mov_b32 v213, -1
    v_mov_b32 v214, -1
    v_mov_b32 v215, -1
    v_lshlrev_b32_e64 v3, 4, v1
    s_lshl_b32 s99, s79, 16
    s_add_u32 s99, s99, 8716288
    s_lshl_b32 s96, s78, 4
    s_add_u32 s96, s96, s77
    s_lshl_b32 s96, s96, 12
    s_add_u32 s96, s96, 8716288
    s_lshl_b32 s4, s76, 10
    s_add_u32 s95, s4, s96
    s_mov_b32 s56, s44
    s_and_b32 s57, s45, 0xffff
    s_mov_b32 s58, 256
    s_mov_b32 s59, 0x00020000
    s_mov_b32 s52, s42
    s_and_b32 s53, s43, 0xffff
    s_mov_b32 s54, 5242880
    s_mov_b32 s55, 0x00020000
    v_and_b32 v209, 15, v1
    v_bfe_u32 v210, v1, 4, 1
    v_bfe_u32 v200, v1, 1, 1
    v_lshl_add_u32 v210, v210, 1, v200
    v_bfe_u32 v211, v1, 2, 2
    v_lshrrev_b32 v2, 5, v1
    v_lshlrev_b32 v200, 3, v210
    v_and_b32 v201, 1, v1
    v_mul_u32_u24 v201, 5, v201
    v_lshlrev_b32_e64 v202, 11, v2
    v_lshl_add_u32 v202, v211, 8, v202
    s_mov_b32 s9, 235143680
    v_bfe_u32 v203, s9, v200, 8
    v_add_u32 v203, v203, v201
    v_min_u32 v203, 31, v203
    v_lshl_add_u32 v203, v211, 3, v203
    v_and_b32_e64 v203, 31, v203
    v_lshl_add_u32 v228, v203, 3, v202
    s_mov_b32 s9, 386728705
    v_bfe_u32 v203, s9, v200, 8
    v_add_u32 v203, v203, v201
    v_min_u32 v203, 31, v203
    v_lshl_add_u32 v203, v211, 3, v203
    v_and_b32_e64 v203, 31, v203
    v_lshl_add_u32 v229, v203, 3, v202
    s_mov_b32 s9, 404098058
    v_bfe_u32 v203, s9, v200, 8
    v_add_u32 v203, v203, v201
    v_min_u32 v203, 31, v203
    v_lshl_add_u32 v203, v211, 3, v203
    v_and_b32_e64 v203, 31, v203
    v_lshl_add_u32 v230, v203, 3, v202
    s_mov_b32 s9, 504697867
    v_bfe_u32 v203, s9, v200, 8
    v_add_u32 v203, v203, v201
    v_min_u32 v203, 31, v203
    v_lshl_add_u32 v203, v211, 3, v203
    v_and_b32_e64 v203, 31, v203
    v_lshl_add_u32 v231, v203, 3, v202
    v_and_b32_e64 v200, 31, v1
    v_bfe_u32 v201, v1, 1, 3
    v_xor_b32 v201, v201, v2
    v_lshlrev_b32 v200, 7, v200
    v_lshl_add_u32 v200, v201, 4, v200
    v_xor_b32 v232, 0, v200
    v_add_u32 v232, s89, v232
    v_xor_b32 v233, 32, v200
    v_add_u32 v233, s89, v233
    v_xor_b32 v234, 64, v200
    v_add_u32 v234, s89, v234
    v_xor_b32 v235, 96, v200
    v_add_u32_e64 v235, s89, v235
    s_and_b32 s90, s76, 1
    s_lshr_b32 s91, s76, 1
    s_mov_b32 s94, 0x3fb8aa3b
    v_mul_u32_u24 v200, 800, v2
    v_mul_u32_u24_e64 v201, 40, v211
    v_lshl_add_u32 v201, v210, 3, v201
    v_and_b32 v202, 1, v1
    v_cmp_eq_u32_e64 vcc, v202, v2
    s_and_b32 s4, s78, 1
    s_mul_i32 s4, s4, 1600
    v_add3_u32 v203, v200, v201, s4
    v_mov_b32 v196, 3200
    v_cndmask_b32 v196, v196, v203, vcc
    s_and_b32 s4, s79, 1
    s_mul_i32 s4, s4, 1600
    v_add3_u32 v203, v200, v201, s4
    v_mov_b32 v197, 3200
    v_cndmask_b32 v197, v197, v203, vcc
    v_lshlrev_b32 v199, 2, v0
    v_mov_b32 v184, 0
    v_mov_b32 v150, 0
    v_mov_b32 v151, 0
    v_mov_b32 v154, 0
    v_mov_b32 v155, 0
    v_mov_b32 v174, 0
    v_mov_b32 v175, 0
    v_mov_b32 v178, 0
    v_mov_b32_e64 v179, 0
    v_mul_u32_u24 v239, 80, v1
    v_add_u32 v239, s89, v239
    v_mul_u32_u24 v240, 48, v1
    v_add_u32_e64 v240, s89, v240
    v_lshl_add_u32 v200, v2, 3, v211
    v_bfe_u32 v201, v1, 4, 1
    v_lshlrev_b32 v201, 2, v201
    v_and_b32 v202, 1, v1
    v_lshl_add_u32 v202, v202, 1, v201
    v_bfe_u32 v203, v1, 1, 1
    v_add_u32_e64 v202, v202, v203
    v_mul_u32_u24 v241, 80, v200
    v_lshl_add_u32 v241, v202, 3, v241
    s_mul_i32 s4, s90, 2560
    s_lshl_b32 s5, s91, 6
    s_add_u32 s4, s4, s5
    s_add_u32 s4, s4, 49152
    v_add_u32 v241, s4, v241
    v_and_b32 v202, 3, v1
    v_add_u32 v202, v202, v201
    v_mul_u32_u24 v242, 48, v200
    v_lshl_add_u32 v242, v202, 3, v242
    s_mul_i32 s4, s90, 1536
    s_add_u32 s4, s4, 54272
    v_add_u32 v242, s4, v242
    v_and_b32 v200, 31, v1
    s_lshl_b32 s4, s90, 4
    v_add_u32 v201, s4, v200
    v_subrev_u32 v202, 20, v201
    v_min_u32 v201, v201, v202
    v_cmp_gt_u32_e64 vcc, 20, v200
    v_mov_b32 v203, 0x4000000
    s_nop 0
    v_cndmask_b32 v201, v200, v201, vcc
    v_lshlrev_b32 v201, 4, v201
    v_cmp_gt_u32_e64 vcc, 24, v200
    s_cmp_eq_u32 s91, 0
    s_mov_b32 s9, 0x4000000
    s_cselect_b32 s4, 384, s9
    s_cselect_b32 s5, 768, s9
    v_cndmask_b32_e64 v201, v203, v201, vcc
    v_mul_lo_u32 v243, v2, s4
    v_add_u32 v243, v243, v201
    v_add_u32 v244, s5, v243
    s_mul_i32 s4, s90, 1920
    s_mul_i32 s5, s91, 1536
    s_add_u32 s96, s96, s4
    s_add_u32 s96, s96, s5
    v_min_u32 v245, 239, v0
    v_lshlrev_b32_e64 v245, 4, v245
    v_bfe_u32 v200, v1, 3, 2
    v_and_b32_e64 v201, 3, v1
    v_lshl_add_u32 v200, v200, 2, v201
    v_mul_u32_u24 v201, 1920, v2
    v_lshl_add_u32 v202, v200, 4, v201
    v_add_u32 v202, 45056, v202
    v_bfe_u32 v201, v1, 2, 1
    v_cmp_eq_u32_e64 vcc, v201, v2
    v_mov_b32 v246, 40064
    s_nop 0
    v_cndmask_b32 v246, v246, v202, vcc
    v_cndmask_b32 v200, 64, v200, vcc
    v_and_b32 v201, 1, v200
    v_lshlrev_b32_e64 v201, 4, v201
    v_mov_b32 v202, 0x3f80
    v_lshlrev_b32 v201, v201, v202
    v_lshrrev_b32 v200, 1, v200
    v_cmp_eq_u32 vcc, 0, v200
    s_nop 1
    v_cndmask_b32 v216, 0, v201, vcc
    v_cmp_eq_u32 vcc, 1, v200
    s_nop 1
    v_cndmask_b32 v217, 0, v201, vcc
    v_cmp_eq_u32 vcc, 2, v200
    s_nop 1
    v_cndmask_b32 v218, 0, v201, vcc
    v_cmp_eq_u32 vcc, 3, v200
    s_nop 1
    v_cndmask_b32 v219, 0, v201, vcc
    v_and_b32_e64 v201, 1, v208
    v_mul_u32_u24 v201, 20480, v201
    v_lshl_add_u32 v201, v209, 4, v201
    v_mul_u32_u24 v247, 768, v2
    v_add_u32_e64 v247, v247, v201
    v_lshl_add_u32 v248, v2, 26, v201
    s_lshl_b32 s4, s77, 2
    s_add_u32 s4, s4, s76
    s_mul_i32 s4, s4, 40960
    s_mul_i32 s5, s79, 1280
    s_add_u32 s4, s4, s5
    s_add_u32 s97, s4, 5242880
    v_lshlrev_b32_e64 v249, 2, v209
    s_lshl_b32 s98, s80, 3
    s_add_u32 s98, s98, s81
    s_lshl_b32 s98, s98, 2
    s_add_u32 s98, s98, s76
    s_lshl_b32 s98, s98, 7
    s_add_u32 s98, s98, 10158080
    s_mul_i32 s100, s80, 81920
    s_mul_i32 s4, s76, 5120
    s_add_u32 s100, s100, s4
    s_add_u32 s100, s100, 5242880
    s_lshl_b32 s101, s81, 2
    s_add_u32 s101, s101, s76
    s_mul_i32 s101, s101, 25600
    s_add_u32 s101, s101, 7864320
    v_mul_u32_u24 v250, 160, v209
    v_mul_u32_u24 v201, 40, v208
    s_mul_i32 s93, s76, 2560
    s_add_u32 s4, s93, 30720
    v_add3_u32 v250, v250, v201, s4
    v_add_u32_e64 v200, 0, v1
    v_mul_u32_u24 v201, 6554, v200
    v_lshrrev_b32_e64 v201, 16, v201
    v_mul_u32_u24 v201, 2400, v201
    v_lshl_add_u32 v251, v200, 4, v201
    v_add_u32_e64 v200, 64, v1
    v_mul_u32_u24 v201, 6554, v200
    v_lshrrev_b32_e64 v201, 16, v201
    v_mul_u32_u24 v201, 2400, v201
    v_lshl_add_u32 v252, v200, 4, v201
    v_add_u32 v200, 128, v1
    v_mul_u32_u24 v201, 6554, v200
    v_lshrrev_b32_e64 v201, 16, v201
    v_mul_u32_u24 v201, 2400, v201
    v_lshl_add_u32 v253, v200, 4, v201
    s_add_u32 s22, s76, s81
    s_and_b32 s22, s22, 3
    s_lshl_b32 s46, s80, 2
    s_add_u32 s46, s46, s22
    s_mul_i32 s46, s46, 40960
    s_mul_i32 s5, s81, 160
    s_add_u32 s46, s46, s5
    s_lshl_b32 s47, s78, 13
    s_lshr_b32 s5, s77, 2
    s_lshl_b32 s5, s5, 7
    s_add_u32 s47, s47, s5
    s_and_b32 s5, s77, 3
    s_lshl_b32 s5, s5, 2
    s_add_u32 s47, s47, s5
    s_add_u32 s47, s47, 10027008
    s_lshl_b32 s92, s79, 4
    s_add_u32 s92, s92, s77
    s_lshl_b32 s92, s92, 9
    s_add_u32 s92, s92, 10027008
    s_lshl_b32 s3, s77, 1
    s_add_u32 s3, s3, s91
    s_lshl_b32 s3, s3, 12
    s_lshr_b32 s5, s79, 2
    s_lshl_b32 s5, s5, 7
    s_add_u32 s3, s3, s5
    s_and_b32 s5, s79, 3
    s_lshl_b32 s5, s5, 2
    s_add_u32 s3, s3, s5
    s_add_u32 s3, s3, 10158080
    s_lshl_b32 s5, s76, 7
    s_add_u32 s92, s5, s92
    s_buffer_load_dword s23, s[48:51], s92 glc
    s_buffer_load_dword s23, s[48:51], s98 glc
    s_mul_i32 s4, s76, 20
    v_min_u32 v200, 19, v1
    v_add_u32 v200, s4, v200
    v_lshrrev_b32 v201, 3, v200
    v_and_b32 v200, 7, v200
    v_lshlrev_b32 v200, 2, v200
    v_lshl_add_u32 v195, v201, 7, v200
    s_mov_b32 s45, 10289152
    s_lshl_b32 s39, s2, 2
    s_add_u32 s39, s39, s76
    s_lshl_b32 s39, s39, 7
    s_add_u32 s39, s39, 9764896
    s_cmp_ge_u32 s2, 160
    s_cselect_b32 s39, 16777216, s39
    v_and_b32 v254, 4, v249
    s_and_b32 s4, s80, 3
    s_lshl_b32 s40, s4, 10
    s_mul_i32 s16, s4, 5120
    s_add_u32 s16, s16, s101
    s_add_u32 s4, s4, 1
    s_cmp_eq_u32 s4, 5
    s_cselect_b32 s4, 0, s4
    s_lshl_b32 s41, s4, 10
    s_mul_i32 s17, s4, 5120
    s_add_u32 s17, s17, s101
    s_add_u32 s4, s4, 1
    s_cmp_eq_u32 s4, 5
    s_cselect_b32 s4, 0, s4
    s_lshl_b32 s42, s4, 10
    s_mul_i32 s18, s4, 5120
    s_add_u32 s18, s18, s101
    s_add_u32 s4, s4, 1
    s_cmp_eq_u32 s4, 5
    s_cselect_b32 s4, 0, s4
    s_lshl_b32 s43, s4, 10
    s_mul_i32 s19, s4, 5120
    s_add_u32 s19, s19, s101
    s_add_u32 s4, s4, 1
    s_cmp_eq_u32 s4, 5
    s_cselect_b32 s4, 0, s4
    s_lshl_b32 s44, s4, 10
    s_mul_i32 s20, s4, 5120
    s_add_u32 s20, s20, s101
    s_waitcnt vmcnt(9)
    s_barrier
    s_nop 0
    ds_read_b128 v[100:103], v232 offset:0
    ds_read_b128 v[104:107], v233 offset:0
    ds_read_b128 v[108:111], v234 offset:0
    ds_read_b128 v[112:115], v235 offset:0
    ds_read_b64_tr_b16 v[68:69], v228 offset:16384
    ds_read_b64_tr_b16 v[70:71], v228 offset:17408
    ds_read_b64_tr_b16 v[72:73], v229 offset:16384
    ds_read_b64_tr_b16 v[74:75], v229 offset:17408
    ds_read_b64_tr_b16 v[76:77], v230 offset:16384
    ds_read_b64_tr_b16 v[78:79], v230 offset:17408
    ds_read_b64_tr_b16 v[80:81], v231 offset:16384
    ds_read_b64_tr_b16 v[82:83], v231 offset:17408
    s_add_u32 m0, s88, 0
    s_nop 0
    buffer_load_dwordx4 v224, s[64:67], s84 offen offset:0 lds
    buffer_load_dwordx4 v225, s[64:67], s84 offen offset:1024 lds
    s_waitcnt lgkmcnt(0)
    s_nop 0
    v_mfma_f32_32x32x16_bf16 v[4:19], v[68:71], v[100:103], 0
    ds_read_b64_tr_b16 v[84:85], v228 offset:20480
    ds_read_b64_tr_b16 v[86:87], v228 offset:21504
    ds_read_b64_tr_b16 v[88:89], v229 offset:20480
    v_mfma_f32_32x32x16_bf16 v[20:35], v[72:75], v[100:103], 0
    ds_read_b64_tr_b16 v[90:91], v229 offset:21504
    ds_read_b64_tr_b16 v[92:93], v230 offset:20480
    ds_read_b64_tr_b16 v[94:95], v230 offset:21504
    buffer_load_dwordx4 v226, s[64:67], s84 offen offset:2048 lds
    v_mfma_f32_32x32x16_bf16 v[36:51], v[76:79], v[100:103], 0
    ds_read_b64_tr_b16 v[96:97], v231 offset:20480
    ds_read_b64_tr_b16 v[98:99], v231 offset:21504
    v_mfma_f32_32x32x16_bf16 v[52:67], v[80:83], v[100:103], 0
    buffer_load_dwordx4 v227, s[64:67], s84 offen offset:3072 lds
    s_add_u32 s84, s84, 245760
    s_cmp_ge_u32 s84, s86
    s_cselect_b32 s9, 2457600, 0
    s_sub_u32 s84, s84, s9
    s_waitcnt lgkmcnt(6)
    v_mfma_f32_32x32x16_bf16 v[4:19], v[84:87], v[104:107], v[4:19]
    ds_read_b64_tr_b16 v[68:69], v228 offset:24576
    ds_read_b64_tr_b16 v[70:71], v228 offset:25600
    ds_read_b64_tr_b16 v[72:73], v229 offset:24576
    s_waitcnt lgkmcnt(7)
    v_mfma_f32_32x32x16_bf16 v[20:35], v[88:91], v[104:107], v[20:35]
    ds_read_b64_tr_b16 v[74:75], v229 offset:25600
    ds_read_b64_tr_b16 v[76:77], v230 offset:24576
    ds_read_b64_tr_b16 v[78:79], v230 offset:25600
    s_add_u32 m0, s89, 0
    s_nop 0
    buffer_load_dwordx4 v220, s[60:63], s85 offen offset:0 lds
    s_waitcnt lgkmcnt(8)
    v_mfma_f32_32x32x16_bf16 v[36:51], v[92:95], v[104:107], v[36:51]
    ds_read_b64_tr_b16 v[80:81], v231 offset:24576
    ds_read_b64_tr_b16 v[82:83], v231 offset:25600
    s_waitcnt lgkmcnt(8)
    v_mfma_f32_32x32x16_bf16 v[52:67], v[96:99], v[104:107], v[52:67]
    buffer_load_dwordx4 v221, s[60:63], s85 offen offset:1024 lds
    s_waitcnt lgkmcnt(6)
    v_mfma_f32_32x32x16_bf16 v[4:19], v[68:71], v[108:111], v[4:19]
    ds_read_b64_tr_b16 v[84:85], v228 offset:28672
    ds_read_b64_tr_b16 v[86:87], v228 offset:29696
    ds_read_b64_tr_b16 v[88:89], v229 offset:28672
    s_waitcnt lgkmcnt(7)
    v_mfma_f32_32x32x16_bf16 v[20:35], v[72:75], v[108:111], v[20:35]
    ds_read_b64_tr_b16 v[90:91], v229 offset:29696
    ds_read_b64_tr_b16 v[92:93], v230 offset:28672
    ds_read_b64_tr_b16 v[94:95], v230 offset:29696
    buffer_load_dwordx4 v222, s[60:63], s85 offen offset:2048 lds
    s_waitcnt lgkmcnt(8)
    v_mfma_f32_32x32x16_bf16 v[36:51], v[76:79], v[108:111], v[36:51]
    ds_read_b64_tr_b16 v[96:97], v231 offset:28672
    ds_read_b64_tr_b16 v[98:99], v231 offset:29696
    s_waitcnt lgkmcnt(8)
    v_mfma_f32_32x32x16_bf16 v[52:67], v[80:83], v[108:111], v[52:67]
    buffer_load_dwordx4 v223, s[60:63], s85 offen offset:3072 lds
    s_add_u32 s85, s85, 128
    s_cmp_ge_u32 s85, s87
    s_cselect_b32 s9, 1280, 0
    s_sub_u32 s85, s85, s9
    s_waitcnt vmcnt(8)
    s_waitcnt lgkmcnt(0)
    s_barrier
    s_nop 0
    v_mfma_f32_32x32x16_bf16 v[4:19], v[84:87], v[112:115], v[4:19]
    ds_read_b128 v[116:119], v232 offset:4096
    ds_read_b64_tr_b16 v[68:69], v228 offset:32768
    ds_read_b64_tr_b16 v[70:71], v228 offset:33792
    ds_read_b64_tr_b16 v[72:73], v229 offset:32768
    v_mfma_f32_32x32x16_bf16 v[20:35], v[88:91], v[112:115], v[20:35]
    ds_read_b64_tr_b16 v[74:75], v229 offset:33792
    ds_read_b64_tr_b16 v[76:77], v230 offset:32768
    ds_read_b64_tr_b16 v[78:79], v230 offset:33792
    ds_read_b64_tr_b16 v[80:81], v231 offset:32768
    s_add_u32 m0, s88, 16384
    s_nop 0
    s_nop 0
    buffer_load_dwordx4 v224, s[64:67], s84 offen offset:0 lds
    v_mfma_f32_32x32x16_bf16 v[36:51], v[92:95], v[112:115], v[36:51]
    ds_read_b64_tr_b16 v[82:83], v231 offset:33792
    ds_read_b128 v[120:123], v233 offset:4096
    ds_read_b128 v[124:127], v234 offset:4096
    ds_read_b128 v[128:131], v235 offset:4096
    v_mfma_f32_32x32x16_bf16 v[52:67], v[96:99], v[112:115], v[52:67]
    buffer_load_dwordx4 v225, s[64:67], s84 offen offset:1024 lds
    s_waitcnt lgkmcnt(9)
    v_mfma_f32_32x32x16_bf16 v[4:19], v[68:71], v[116:119], v[4:19]
    ds_read_b64_tr_b16 v[84:85], v228 offset:36864
    ds_read_b64_tr_b16 v[86:87], v228 offset:37888
    ds_read_b64_tr_b16 v[88:89], v229 offset:36864
    s_waitcnt lgkmcnt(10)
    v_mfma_f32_32x32x16_bf16 v[20:35], v[72:75], v[116:119], v[20:35]
    ds_read_b64_tr_b16 v[90:91], v229 offset:37888
    ds_read_b64_tr_b16 v[92:93], v230 offset:36864
    ds_read_b64_tr_b16 v[94:95], v230 offset:37888
    buffer_load_dwordx4 v226, s[64:67], s84 offen offset:2048 lds
    s_waitcnt lgkmcnt(11)
    v_mfma_f32_32x32x16_bf16 v[36:51], v[76:79], v[116:119], v[36:51]
    ds_read_b64_tr_b16 v[96:97], v231 offset:36864
    ds_read_b64_tr_b16 v[98:99], v231 offset:37888
    s_waitcnt lgkmcnt(11)
    v_mfma_f32_32x32x16_bf16 v[52:67], v[80:83], v[116:119], v[52:67]
    buffer_load_dwordx4 v227, s[64:67], s84 offen offset:3072 lds
    s_add_u32 s84, s84, 245760
    s_cmp_ge_u32 s84, s86
    s_cselect_b32 s9, 2457600, 0
    s_sub_u32 s84, s84, s9
    s_waitcnt lgkmcnt(6)
    v_mfma_f32_32x32x16_bf16 v[4:19], v[84:87], v[120:123], v[4:19]
    ds_read_b64_tr_b16 v[68:69], v228 offset:40960
    ds_read_b64_tr_b16 v[70:71], v228 offset:41984
    ds_read_b64_tr_b16 v[72:73], v229 offset:40960
    s_waitcnt lgkmcnt(7)
    v_mfma_f32_32x32x16_bf16 v[20:35], v[88:91], v[120:123], v[20:35]
    ds_read_b64_tr_b16 v[74:75], v229 offset:41984
    ds_read_b64_tr_b16 v[76:77], v230 offset:40960
    ds_read_b64_tr_b16 v[78:79], v230 offset:41984
    s_add_u32 m0, s89, 4096
    s_nop 0
    buffer_load_dwordx4 v220, s[60:63], s85 offen offset:0 lds
    s_waitcnt lgkmcnt(8)
    v_mfma_f32_32x32x16_bf16 v[36:51], v[92:95], v[120:123], v[36:51]
    ds_read_b64_tr_b16 v[80:81], v231 offset:40960
    ds_read_b64_tr_b16 v[82:83], v231 offset:41984
    s_waitcnt lgkmcnt(8)
    v_mfma_f32_32x32x16_bf16 v[52:67], v[96:99], v[120:123], v[52:67]
    buffer_load_dwordx4 v221, s[60:63], s85 offen offset:1024 lds
    s_waitcnt lgkmcnt(6)
    v_mfma_f32_32x32x16_bf16 v[4:19], v[68:71], v[124:127], v[4:19]
    ds_read_b64_tr_b16 v[84:85], v228 offset:45056
    ds_read_b64_tr_b16 v[86:87], v228 offset:46080
    ds_read_b64_tr_b16 v[88:89], v229 offset:45056
    s_waitcnt lgkmcnt(7)
    s_nop 0
    v_mfma_f32_32x32x16_bf16 v[20:35], v[72:75], v[124:127], v[20:35]
    ds_read_b64_tr_b16 v[90:91], v229 offset:46080
    ds_read_b64_tr_b16 v[92:93], v230 offset:45056
    ds_read_b64_tr_b16 v[94:95], v230 offset:46080
    buffer_load_dwordx4 v222, s[60:63], s85 offen offset:2048 lds
    s_waitcnt lgkmcnt(8)
    v_mfma_f32_32x32x16_bf16 v[36:51], v[76:79], v[124:127], v[36:51]
    ds_read_b64_tr_b16 v[96:97], v231 offset:45056
    ds_read_b64_tr_b16 v[98:99], v231 offset:46080
    s_waitcnt lgkmcnt(8)
    v_mfma_f32_32x32x16_bf16 v[52:67], v[80:83], v[124:127], v[52:67]
    buffer_load_dwordx4 v223, s[60:63], s85 offen offset:3072 lds
    s_add_u32 s85, s85, 128
    s_cmp_ge_u32 s85, s87
    s_cselect_b32 s9, 1280, 0
    s_sub_u32 s85, s85, s9
    s_waitcnt vmcnt(8)
    s_waitcnt lgkmcnt(0)
    s_barrier
    s_nop 0
    v_mfma_f32_32x32x16_bf16 v[4:19], v[84:87], v[128:131], v[4:19]
    ds_read_b128 v[100:103], v232 offset:0
    ds_read_b64_tr_b16 v[68:69], v228 offset:0
    ds_read_b64_tr_b16 v[70:71], v228 offset:1024
    ds_read_b64_tr_b16 v[72:73], v229 offset:0
    v_mfma_f32_32x32x16_bf16 v[20:35], v[88:91], v[128:131], v[20:35]
    ds_read_b64_tr_b16 v[74:75], v229 offset:1024
    ds_read_b64_tr_b16 v[76:77], v230 offset:0
    ds_read_b64_tr_b16 v[78:79], v230 offset:1024
    ds_read_b64_tr_b16 v[80:81], v231 offset:0
    s_add_u32 m0, s88, 32768
    s_nop 0
    s_nop 0
    buffer_load_dwordx4 v224, s[64:67], s84 offen offset:0 lds
    v_mfma_f32_32x32x16_bf16 v[36:51], v[92:95], v[128:131], v[36:51]
    ds_read_b64_tr_b16 v[82:83], v231 offset:1024
    ds_read_b128 v[104:107], v233 offset:0
    ds_read_b128 v[108:111], v234 offset:0
    ds_read_b128 v[112:115], v235 offset:0
    v_mfma_f32_32x32x16_bf16 v[52:67], v[96:99], v[128:131], v[52:67]
    buffer_load_dwordx4 v225, s[64:67], s84 offen offset:1024 lds
    s_waitcnt lgkmcnt(9)
    v_mfma_f32_32x32x16_bf16 v[4:19], v[68:71], v[100:103], v[4:19]
    ds_read_b64_tr_b16 v[84:85], v228 offset:4096
    ds_read_b64_tr_b16 v[86:87], v228 offset:5120
    ds_read_b64_tr_b16 v[88:89], v229 offset:4096
    s_waitcnt lgkmcnt(10)
    v_mfma_f32_32x32x16_bf16 v[20:35], v[72:75], v[100:103], v[20:35]
    ds_read_b64_tr_b16 v[90:91], v229 offset:5120
    ds_read_b64_tr_b16 v[92:93], v230 offset:4096
    ds_read_b64_tr_b16 v[94:95], v230 offset:5120
    buffer_load_dwordx4 v226, s[64:67], s84 offen offset:2048 lds
    s_waitcnt lgkmcnt(11)
    v_mfma_f32_32x32x16_bf16 v[36:51], v[76:79], v[100:103], v[36:51]
    ds_read_b64_tr_b16 v[96:97], v231 offset:4096
    ds_read_b64_tr_b16 v[98:99], v231 offset:5120
    s_waitcnt lgkmcnt(11)
    v_mfma_f32_32x32x16_bf16 v[52:67], v[80:83], v[100:103], v[52:67]
    buffer_load_dwordx4 v227, s[64:67], s84 offen offset:3072 lds
    s_add_u32 s84, s84, 245760
    s_cmp_ge_u32 s84, s86
    s_cselect_b32 s9, 2457600, 0
    s_sub_u32 s84, s84, s9
    s_waitcnt lgkmcnt(6)
    v_mfma_f32_32x32x16_bf16 v[4:19], v[84:87], v[104:107], v[4:19]
    ds_read_b64_tr_b16 v[68:69], v228 offset:8192
    ds_read_b64_tr_b16 v[70:71], v228 offset:9216
    ds_read_b64_tr_b16 v[72:73], v229 offset:8192
    s_waitcnt lgkmcnt(7)
    v_mfma_f32_32x32x16_bf16 v[20:35], v[88:91], v[104:107], v[20:35]
    ds_read_b64_tr_b16 v[74:75], v229 offset:9216
    ds_read_b64_tr_b16 v[76:77], v230 offset:8192
    ds_read_b64_tr_b16 v[78:79], v230 offset:9216
    s_add_u32 m0, s89, 0
    s_nop 0
    buffer_load_dwordx4 v220, s[60:63], s85 offen offset:0 lds
    s_waitcnt lgkmcnt(8)
    v_mfma_f32_32x32x16_bf16 v[36:51], v[92:95], v[104:107], v[36:51]
    ds_read_b64_tr_b16 v[80:81], v231 offset:8192
    ds_read_b64_tr_b16 v[82:83], v231 offset:9216
    s_waitcnt lgkmcnt(8)
    v_mfma_f32_32x32x16_bf16 v[52:67], v[96:99], v[104:107], v[52:67]
    buffer_load_dwordx4 v221, s[60:63], s85 offen offset:1024 lds
    s_waitcnt lgkmcnt(6)
    v_mfma_f32_32x32x16_bf16 v[4:19], v[68:71], v[108:111], v[4:19]
    ds_read_b64_tr_b16 v[84:85], v228 offset:12288
    ds_read_b64_tr_b16 v[86:87], v228 offset:13312
    ds_read_b64_tr_b16 v[88:89], v229 offset:12288
    s_waitcnt lgkmcnt(7)
    v_mfma_f32_32x32x16_bf16 v[20:35], v[72:75], v[108:111], v[20:35]
    ds_read_b64_tr_b16 v[90:91], v229 offset:13312
    ds_read_b64_tr_b16 v[92:93], v230 offset:12288
    ds_read_b64_tr_b16 v[94:95], v230 offset:13312
    buffer_load_dwordx4 v222, s[60:63], s85 offen offset:2048 lds
    s_waitcnt lgkmcnt(8)
    v_mfma_f32_32x32x16_bf16 v[36:51], v[76:79], v[108:111], v[36:51]
    ds_read_b64_tr_b16 v[96:97], v231 offset:12288
    ds_read_b64_tr_b16 v[98:99], v231 offset:13312
    s_waitcnt lgkmcnt(8)
    v_mfma_f32_32x32x16_bf16 v[52:67], v[80:83], v[108:111], v[52:67]
    buffer_load_dwordx4 v223, s[60:63], s85 offen offset:3072 lds
    s_add_u32 s85, s85, 128
    s_cmp_ge_u32 s85, s87
    s_cselect_b32 s9, 1280, 0
    s_sub_u32 s85, s85, s9
    s_waitcnt vmcnt(8)
    s_waitcnt lgkmcnt(0)
    s_barrier
    s_nop 0
    v_mfma_f32_32x32x16_bf16 v[4:19], v[84:87], v[112:115], v[4:19]
    ds_read_b128 v[116:119], v232 offset:4096
    ds_read_b64_tr_b16 v[68:69], v228 offset:16384
    ds_read_b64_tr_b16 v[70:71], v228 offset:17408
    ds_read_b64_tr_b16 v[72:73], v229 offset:16384
    v_mfma_f32_32x32x16_bf16 v[20:35], v[88:91], v[112:115], v[20:35]
    ds_read_b64_tr_b16 v[74:75], v229 offset:17408
    ds_read_b64_tr_b16 v[76:77], v230 offset:16384
    ds_read_b64_tr_b16 v[78:79], v230 offset:17408
    ds_read_b64_tr_b16 v[80:81], v231 offset:16384
    s_add_u32 m0, s88, 0
    s_nop 0
    buffer_load_dwordx4 v224, s[64:67], s84 offen offset:0 lds
    v_mfma_f32_32x32x16_bf16 v[36:51], v[92:95], v[112:115], v[36:51]
    ds_read_b64_tr_b16 v[82:83], v231 offset:17408
    ds_read_b128 v[120:123], v233 offset:4096
    ds_read_b128 v[124:127], v234 offset:4096
    ds_read_b128 v[128:131], v235 offset:4096
    v_mfma_f32_32x32x16_bf16 v[52:67], v[96:99], v[112:115], v[52:67]
    buffer_load_dwordx4 v225, s[64:67], s84 offen offset:1024 lds
    s_waitcnt lgkmcnt(9)
    v_mfma_f32_32x32x16_bf16 v[4:19], v[68:71], v[116:119], v[4:19]
    ds_read_b64_tr_b16 v[84:85], v228 offset:20480
    ds_read_b64_tr_b16 v[86:87], v228 offset:21504
    ds_read_b64_tr_b16 v[88:89], v229 offset:20480
    s_waitcnt lgkmcnt(10)
    v_mfma_f32_32x32x16_bf16 v[20:35], v[72:75], v[116:119], v[20:35]
    ds_read_b64_tr_b16 v[90:91], v229 offset:21504
    ds_read_b64_tr_b16 v[92:93], v230 offset:20480
    ds_read_b64_tr_b16 v[94:95], v230 offset:21504
    buffer_load_dwordx4 v226, s[64:67], s84 offen offset:2048 lds
    s_waitcnt lgkmcnt(11)
    v_mfma_f32_32x32x16_bf16 v[36:51], v[76:79], v[116:119], v[36:51]
    ds_read_b64_tr_b16 v[96:97], v231 offset:20480
    ds_read_b64_tr_b16 v[98:99], v231 offset:21504
    s_waitcnt lgkmcnt(11)
    v_mfma_f32_32x32x16_bf16 v[52:67], v[80:83], v[116:119], v[52:67]
    buffer_load_dwordx4 v227, s[64:67], s84 offen offset:3072 lds
    s_add_u32 s84, s84, 245760
    s_cmp_ge_u32 s84, s86
    s_cselect_b32 s9, 2457600, 0
    s_sub_u32 s84, s84, s9
    s_waitcnt lgkmcnt(6)
    v_mfma_f32_32x32x16_bf16 v[4:19], v[84:87], v[120:123], v[4:19]
    ds_read_b64_tr_b16 v[68:69], v228 offset:24576
    ds_read_b64_tr_b16 v[70:71], v228 offset:25600
    ds_read_b64_tr_b16 v[72:73], v229 offset:24576
    s_waitcnt lgkmcnt(7)
    v_mfma_f32_32x32x16_bf16 v[20:35], v[88:91], v[120:123], v[20:35]
    ds_read_b64_tr_b16 v[74:75], v229 offset:25600
    ds_read_b64_tr_b16 v[76:77], v230 offset:24576
    ds_read_b64_tr_b16 v[78:79], v230 offset:25600
    s_add_u32 m0, s89, 4096
    s_nop 0
    buffer_load_dwordx4 v220, s[60:63], s85 offen offset:0 lds
    s_waitcnt lgkmcnt(8)
    v_mfma_f32_32x32x16_bf16 v[36:51], v[92:95], v[120:123], v[36:51]
    ds_read_b64_tr_b16 v[80:81], v231 offset:24576
    ds_read_b64_tr_b16 v[82:83], v231 offset:25600
    s_waitcnt lgkmcnt(8)
    v_mfma_f32_32x32x16_bf16 v[52:67], v[96:99], v[120:123], v[52:67]
    buffer_load_dwordx4 v221, s[60:63], s85 offen offset:1024 lds
    s_waitcnt lgkmcnt(6)
    v_mfma_f32_32x32x16_bf16 v[4:19], v[68:71], v[124:127], v[4:19]
    ds_read_b64_tr_b16 v[84:85], v228 offset:28672
    ds_read_b64_tr_b16 v[86:87], v228 offset:29696
    ds_read_b64_tr_b16 v[88:89], v229 offset:28672
    s_waitcnt lgkmcnt(7)
    s_nop 0
    v_mfma_f32_32x32x16_bf16 v[20:35], v[72:75], v[124:127], v[20:35]
    ds_read_b64_tr_b16 v[90:91], v229 offset:29696
    ds_read_b64_tr_b16 v[92:93], v230 offset:28672
    ds_read_b64_tr_b16 v[94:95], v230 offset:29696
    buffer_load_dwordx4 v222, s[60:63], s85 offen offset:2048 lds
    s_waitcnt lgkmcnt(8)
    v_mfma_f32_32x32x16_bf16 v[36:51], v[76:79], v[124:127], v[36:51]
    ds_read_b64_tr_b16 v[96:97], v231 offset:28672
    ds_read_b64_tr_b16 v[98:99], v231 offset:29696
    s_waitcnt lgkmcnt(8)
    v_mfma_f32_32x32x16_bf16 v[52:67], v[80:83], v[124:127], v[52:67]
    buffer_load_dwordx4 v223, s[60:63], s85 offen offset:3072 lds
    s_add_u32 s85, s85, 128
    s_cmp_ge_u32 s85, s87
    s_cselect_b32 s9, 1280, 0
    s_sub_u32 s85, s85, s9
    s_waitcnt vmcnt(8)
    s_waitcnt lgkmcnt(0)
    s_barrier
    s_nop 0
    v_mfma_f32_32x32x16_bf16 v[4:19], v[84:87], v[128:131], v[4:19]
    ds_read_b128 v[100:103], v232 offset:0
    ds_read_b64_tr_b16 v[68:69], v228 offset:32768
    ds_read_b64_tr_b16 v[70:71], v228 offset:33792
    ds_read_b64_tr_b16 v[72:73], v229 offset:32768
    v_mfma_f32_32x32x16_bf16 v[20:35], v[88:91], v[128:131], v[20:35]
    ds_read_b64_tr_b16 v[74:75], v229 offset:33792
    ds_read_b64_tr_b16 v[76:77], v230 offset:32768
    ds_read_b64_tr_b16 v[78:79], v230 offset:33792
    ds_read_b64_tr_b16 v[80:81], v231 offset:32768
    s_add_u32 m0, s88, 16384
    s_nop 0
    s_nop 0
    buffer_load_dwordx4 v224, s[64:67], s84 offen offset:0 lds
    v_mfma_f32_32x32x16_bf16 v[36:51], v[92:95], v[128:131], v[36:51]
    ds_read_b64_tr_b16 v[82:83], v231 offset:33792
    ds_read_b128 v[104:107], v233 offset:0
    ds_read_b128 v[108:111], v234 offset:0
    ds_read_b128 v[112:115], v235 offset:0
    v_mfma_f32_32x32x16_bf16 v[52:67], v[96:99], v[128:131], v[52:67]
    buffer_load_dwordx4 v225, s[64:67], s84 offen offset:1024 lds
    s_waitcnt lgkmcnt(9)
    v_mfma_f32_32x32x16_bf16 v[4:19], v[68:71], v[100:103], v[4:19]
    ds_read_b64_tr_b16 v[84:85], v228 offset:36864
    ds_read_b64_tr_b16 v[86:87], v228 offset:37888
    ds_read_b64_tr_b16 v[88:89], v229 offset:36864
    s_waitcnt lgkmcnt(10)
    v_mfma_f32_32x32x16_bf16 v[20:35], v[72:75], v[100:103], v[20:35]
    ds_read_b64_tr_b16 v[90:91], v229 offset:37888
    ds_read_b64_tr_b16 v[92:93], v230 offset:36864
    ds_read_b64_tr_b16 v[94:95], v230 offset:37888
    buffer_load_dwordx4 v226, s[64:67], s84 offen offset:2048 lds
    s_waitcnt lgkmcnt(11)
    v_mfma_f32_32x32x16_bf16 v[36:51], v[76:79], v[100:103], v[36:51]
    ds_read_b64_tr_b16 v[96:97], v231 offset:36864
    ds_read_b64_tr_b16 v[98:99], v231 offset:37888
    s_waitcnt lgkmcnt(11)
    v_mfma_f32_32x32x16_bf16 v[52:67], v[80:83], v[100:103], v[52:67]
    buffer_load_dwordx4 v227, s[64:67], s84 offen offset:3072 lds
    s_add_u32 s84, s84, 245760
    s_cmp_ge_u32 s84, s86
    s_cselect_b32 s9, 2457600, 0
    s_sub_u32 s84, s84, s9
    s_waitcnt lgkmcnt(6)
    v_mfma_f32_32x32x16_bf16 v[4:19], v[84:87], v[104:107], v[4:19]
    ds_read_b64_tr_b16 v[68:69], v228 offset:40960
    ds_read_b64_tr_b16 v[70:71], v228 offset:41984
    ds_read_b64_tr_b16 v[72:73], v229 offset:40960
    s_waitcnt lgkmcnt(7)
    v_mfma_f32_32x32x16_bf16 v[20:35], v[88:91], v[104:107], v[20:35]
    ds_read_b64_tr_b16 v[74:75], v229 offset:41984
    ds_read_b64_tr_b16 v[76:77], v230 offset:40960
    ds_read_b64_tr_b16 v[78:79], v230 offset:41984
    s_add_u32 m0, s89, 0
    s_nop 0
    buffer_load_dwordx4 v220, s[60:63], s85 offen offset:0 lds
    s_waitcnt lgkmcnt(8)
    v_mfma_f32_32x32x16_bf16 v[36:51], v[92:95], v[104:107], v[36:51]
    ds_read_b64_tr_b16 v[80:81], v231 offset:40960
    ds_read_b64_tr_b16 v[82:83], v231 offset:41984
    s_waitcnt lgkmcnt(8)
    v_mfma_f32_32x32x16_bf16 v[52:67], v[96:99], v[104:107], v[52:67]
    buffer_load_dwordx4 v221, s[60:63], s85 offen offset:1024 lds
    s_waitcnt lgkmcnt(6)
    v_mfma_f32_32x32x16_bf16 v[4:19], v[68:71], v[108:111], v[4:19]
    ds_read_b64_tr_b16 v[84:85], v228 offset:45056
    ds_read_b64_tr_b16 v[86:87], v228 offset:46080
    ds_read_b64_tr_b16 v[88:89], v229 offset:45056
    s_waitcnt lgkmcnt(7)
    v_mfma_f32_32x32x16_bf16 v[20:35], v[72:75], v[108:111], v[20:35]
    ds_read_b64_tr_b16 v[90:91], v229 offset:46080
    ds_read_b64_tr_b16 v[92:93], v230 offset:45056
    ds_read_b64_tr_b16 v[94:95], v230 offset:46080
    buffer_load_dwordx4 v222, s[60:63], s85 offen offset:2048 lds
    s_waitcnt lgkmcnt(8)
    v_mfma_f32_32x32x16_bf16 v[36:51], v[76:79], v[108:111], v[36:51]
    ds_read_b64_tr_b16 v[96:97], v231 offset:45056
    ds_read_b64_tr_b16 v[98:99], v231 offset:46080
    s_waitcnt lgkmcnt(8)
    v_mfma_f32_32x32x16_bf16 v[52:67], v[80:83], v[108:111], v[52:67]
    buffer_load_dwordx4 v223, s[60:63], s85 offen offset:3072 lds
    s_add_u32 s85, s85, 128
    s_cmp_ge_u32 s85, s87
    s_cselect_b32 s9, 1280, 0
    s_sub_u32 s85, s85, s9
    s_waitcnt vmcnt(8)
    s_waitcnt lgkmcnt(0)
    s_barrier
    s_nop 0
    v_mfma_f32_32x32x16_bf16 v[4:19], v[84:87], v[112:115], v[4:19]
    ds_read_b128 v[116:119], v232 offset:4096
    ds_read_b64_tr_b16 v[68:69], v228 offset:0
    ds_read_b64_tr_b16 v[70:71], v228 offset:1024
    ds_read_b64_tr_b16 v[72:73], v229 offset:0
    v_mfma_f32_32x32x16_bf16 v[20:35], v[88:91], v[112:115], v[20:35]
    ds_read_b64_tr_b16 v[74:75], v229 offset:1024
    ds_read_b64_tr_b16 v[76:77], v230 offset:0
    ds_read_b64_tr_b16 v[78:79], v230 offset:1024
    ds_read_b64_tr_b16 v[80:81], v231 offset:0
    s_add_u32 m0, s88, 32768
    s_nop 0
    s_nop 0
    buffer_load_dwordx4 v224, s[64:67], s84 offen offset:0 lds
    v_mfma_f32_32x32x16_bf16 v[36:51], v[92:95], v[112:115], v[36:51]
    ds_read_b64_tr_b16 v[82:83], v231 offset:1024
    ds_read_b128 v[120:123], v233 offset:4096
    ds_read_b128 v[124:127], v234 offset:4096
    ds_read_b128 v[128:131], v235 offset:4096
    v_mfma_f32_32x32x16_bf16 v[52:67], v[96:99], v[112:115], v[52:67]
    buffer_load_dwordx4 v225, s[64:67], s84 offen offset:1024 lds
    s_waitcnt lgkmcnt(9)
    v_mfma_f32_32x32x16_bf16 v[4:19], v[68:71], v[116:119], v[4:19]
    ds_read_b64_tr_b16 v[84:85], v228 offset:4096
    ds_read_b64_tr_b16 v[86:87], v228 offset:5120
    ds_read_b64_tr_b16 v[88:89], v229 offset:4096
    s_waitcnt lgkmcnt(10)
    v_mfma_f32_32x32x16_bf16 v[20:35], v[72:75], v[116:119], v[20:35]
    ds_read_b64_tr_b16 v[90:91], v229 offset:5120
    ds_read_b64_tr_b16 v[92:93], v230 offset:4096
    ds_read_b64_tr_b16 v[94:95], v230 offset:5120
    buffer_load_dwordx4 v226, s[64:67], s84 offen offset:2048 lds
    s_waitcnt lgkmcnt(11)
    v_mfma_f32_32x32x16_bf16 v[36:51], v[76:79], v[116:119], v[36:51]
    ds_read_b64_tr_b16 v[96:97], v231 offset:4096
    ds_read_b64_tr_b16 v[98:99], v231 offset:5120
    s_waitcnt lgkmcnt(11)
    v_mfma_f32_32x32x16_bf16 v[52:67], v[80:83], v[116:119], v[52:67]
    buffer_load_dwordx4 v227, s[64:67], s84 offen offset:3072 lds
    s_add_u32 s84, s84, 245760
    s_cmp_ge_u32 s84, s86
    s_cselect_b32 s9, 2457600, 0
    s_sub_u32 s84, s84, s9
    s_waitcnt lgkmcnt(6)
    v_mfma_f32_32x32x16_bf16 v[4:19], v[84:87], v[120:123], v[4:19]
    ds_read_b64_tr_b16 v[68:69], v228 offset:8192
    ds_read_b64_tr_b16 v[70:71], v228 offset:9216
    ds_read_b64_tr_b16 v[72:73], v229 offset:8192
    s_waitcnt lgkmcnt(7)
    v_mfma_f32_32x32x16_bf16 v[20:35], v[88:91], v[120:123], v[20:35]
    ds_read_b64_tr_b16 v[74:75], v229 offset:9216
    ds_read_b64_tr_b16 v[76:77], v230 offset:8192
    ds_read_b64_tr_b16 v[78:79], v230 offset:9216
    s_add_u32 m0, s89, 4096
    s_nop 0
    buffer_load_dwordx4 v220, s[60:63], s85 offen offset:0 lds
    s_waitcnt lgkmcnt(8)
    v_mfma_f32_32x32x16_bf16 v[36:51], v[92:95], v[120:123], v[36:51]
    ds_read_b64_tr_b16 v[80:81], v231 offset:8192
    ds_read_b64_tr_b16 v[82:83], v231 offset:9216
    s_waitcnt lgkmcnt(8)
    v_mfma_f32_32x32x16_bf16 v[52:67], v[96:99], v[120:123], v[52:67]
    buffer_load_dwordx4 v221, s[60:63], s85 offen offset:1024 lds
    s_waitcnt lgkmcnt(6)
    v_mfma_f32_32x32x16_bf16 v[4:19], v[68:71], v[124:127], v[4:19]
    ds_read_b64_tr_b16 v[84:85], v228 offset:12288
    ds_read_b64_tr_b16 v[86:87], v228 offset:13312
    ds_read_b64_tr_b16 v[88:89], v229 offset:12288
    s_waitcnt lgkmcnt(7)
    s_nop 0
    v_mfma_f32_32x32x16_bf16 v[20:35], v[72:75], v[124:127], v[20:35]
    ds_read_b64_tr_b16 v[90:91], v229 offset:13312
    ds_read_b64_tr_b16 v[92:93], v230 offset:12288
    ds_read_b64_tr_b16 v[94:95], v230 offset:13312
    buffer_load_dwordx4 v222, s[60:63], s85 offen offset:2048 lds
    s_waitcnt lgkmcnt(8)
    v_mfma_f32_32x32x16_bf16 v[36:51], v[76:79], v[124:127], v[36:51]
    ds_read_b64_tr_b16 v[96:97], v231 offset:12288
    ds_read_b64_tr_b16 v[98:99], v231 offset:13312
    s_waitcnt lgkmcnt(8)
    v_mfma_f32_32x32x16_bf16 v[52:67], v[80:83], v[124:127], v[52:67]
    buffer_load_dwordx4 v223, s[60:63], s85 offen offset:3072 lds
    s_add_u32 s85, s85, 128
    s_cmp_ge_u32 s85, s87
    s_cselect_b32 s9, 1280, 0
    s_sub_u32 s85, s85, s9
    s_waitcnt vmcnt(8)
    s_waitcnt lgkmcnt(0)
    s_barrier
    s_nop 0
    s_buffer_load_dword s83, s[56:59], 4
    v_mfma_f32_32x32x16_bf16 v[4:19], v[84:87], v[128:131], v[4:19]
    ds_read_b128 v[100:103], v232 offset:0
    ds_read_b64_tr_b16 v[68:69], v228 offset:16384
    ds_read_b64_tr_b16 v[70:71], v228 offset:17408
    ds_read_b64_tr_b16 v[72:73], v229 offset:16384
    v_mfma_f32_32x32x16_bf16 v[20:35], v[88:91], v[128:131], v[20:35]
    ds_read_b64_tr_b16 v[74:75], v229 offset:17408
    ds_read_b64_tr_b16 v[76:77], v230 offset:16384
    ds_read_b64_tr_b16 v[78:79], v230 offset:17408
    ds_read_b64_tr_b16 v[80:81], v231 offset:16384
    s_add_u32 m0, s88, 0
    s_nop 0
    buffer_load_dwordx4 v224, s[64:67], s84 offen offset:0 lds
    v_mfma_f32_32x32x16_bf16 v[36:51], v[92:95], v[128:131], v[36:51]
    ds_read_b64_tr_b16 v[82:83], v231 offset:17408
    ds_read_b128 v[104:107], v233 offset:0
    ds_read_b128 v[108:111], v234 offset:0
    ds_read_b128 v[112:115], v235 offset:0
    v_mfma_f32_32x32x16_bf16 v[52:67], v[96:99], v[128:131], v[52:67]
    buffer_load_dwordx4 v225, s[64:67], s84 offen offset:1024 lds
    s_waitcnt lgkmcnt(9)
    v_mfma_f32_32x32x16_bf16 v[4:19], v[68:71], v[100:103], v[4:19]
    ds_read_b64_tr_b16 v[84:85], v228 offset:20480
    ds_read_b64_tr_b16 v[86:87], v228 offset:21504
    ds_read_b64_tr_b16 v[88:89], v229 offset:20480
    s_waitcnt lgkmcnt(10)
    v_mfma_f32_32x32x16_bf16 v[20:35], v[72:75], v[100:103], v[20:35]
    ds_read_b64_tr_b16 v[90:91], v229 offset:21504
    ds_read_b64_tr_b16 v[92:93], v230 offset:20480
    ds_read_b64_tr_b16 v[94:95], v230 offset:21504
    buffer_load_dwordx4 v226, s[64:67], s84 offen offset:2048 lds
    s_waitcnt lgkmcnt(11)
    v_mfma_f32_32x32x16_bf16 v[36:51], v[76:79], v[100:103], v[36:51]
    ds_read_b64_tr_b16 v[96:97], v231 offset:20480
    ds_read_b64_tr_b16 v[98:99], v231 offset:21504
    s_waitcnt lgkmcnt(11)
    v_mfma_f32_32x32x16_bf16 v[52:67], v[80:83], v[100:103], v[52:67]
    buffer_load_dwordx4 v227, s[64:67], s84 offen offset:3072 lds
    s_add_u32 s84, s84, 245760
    s_cmp_ge_u32 s84, s86
    s_cselect_b32 s9, 2457600, 0
    s_sub_u32 s84, s84, s9
    s_waitcnt lgkmcnt(6)
    v_mfma_f32_32x32x16_bf16 v[4:19], v[84:87], v[104:107], v[4:19]
    ds_read_b64_tr_b16 v[68:69], v228 offset:24576
    ds_read_b64_tr_b16 v[70:71], v228 offset:25600
    ds_read_b64_tr_b16 v[72:73], v229 offset:24576
    s_waitcnt lgkmcnt(7)
    v_mfma_f32_32x32x16_bf16 v[20:35], v[88:91], v[104:107], v[20:35]
    ds_read_b64_tr_b16 v[74:75], v229 offset:25600
    ds_read_b64_tr_b16 v[76:77], v230 offset:24576
    ds_read_b64_tr_b16 v[78:79], v230 offset:25600
    s_add_u32 m0, s89, 0
    s_nop 0
    buffer_load_dwordx4 v220, s[60:63], s85 offen offset:0 lds
    s_waitcnt lgkmcnt(8)
    v_mfma_f32_32x32x16_bf16 v[36:51], v[92:95], v[104:107], v[36:51]
    ds_read_b64_tr_b16 v[80:81], v231 offset:24576
    ds_read_b64_tr_b16 v[82:83], v231 offset:25600
    s_waitcnt lgkmcnt(8)
    v_mfma_f32_32x32x16_bf16 v[52:67], v[96:99], v[104:107], v[52:67]
    buffer_load_dwordx4 v221, s[60:63], s85 offen offset:1024 lds
    s_waitcnt lgkmcnt(6)
    v_mfma_f32_32x32x16_bf16 v[4:19], v[68:71], v[108:111], v[4:19]
    ds_read_b64_tr_b16 v[84:85], v228 offset:28672
    ds_read_b64_tr_b16 v[86:87], v228 offset:29696
    ds_read_b64_tr_b16 v[88:89], v229 offset:28672
    s_waitcnt lgkmcnt(7)
    v_mfma_f32_32x32x16_bf16 v[20:35], v[72:75], v[108:111], v[20:35]
    ds_read_b64_tr_b16 v[90:91], v229 offset:29696
    ds_read_b64_tr_b16 v[92:93], v230 offset:28672
    ds_read_b64_tr_b16 v[94:95], v230 offset:29696
    buffer_load_dwordx4 v222, s[60:63], s85 offen offset:2048 lds
    s_waitcnt lgkmcnt(8)
    v_mfma_f32_32x32x16_bf16 v[36:51], v[76:79], v[108:111], v[36:51]
    ds_read_b64_tr_b16 v[96:97], v231 offset:28672
    ds_read_b64_tr_b16 v[98:99], v231 offset:29696
    s_waitcnt lgkmcnt(8)
    v_mfma_f32_32x32x16_bf16 v[52:67], v[80:83], v[108:111], v[52:67]
    buffer_load_dwordx4 v223, s[60:63], s85 offen offset:3072 lds
    s_add_u32 s85, s85, 128
    s_cmp_ge_u32 s85, s87
    s_cselect_b32 s9, 1280, 0
    s_sub_u32 s85, s85, s9
    s_waitcnt vmcnt(8)
    s_waitcnt lgkmcnt(0)
    s_cmp_lg_u32 s83, 0
    s_cbranch_scc1 L_nok_1
    s_mov_b32 s13, 0
L_nsp_2:
    buffer_load_dword v238, off, s[56:59], 0 offset:4 sc1
    s_add_u32 s13, s13, 1
    s_waitcnt vmcnt(0)
    v_readfirstlane_b32 s83, v238
    s_cmp_gt_u32 s13, 30000
    s_cbranch_scc1 L_nok_1
    s_cmp_eq_u32 s83, 0
    s_cbranch_scc1 L_nsp_2
    s_nop 1
L_nok_1:
    v_mov_b32_e64 v238, s83
    s_waitcnt lgkmcnt(0)
    s_barrier
    v_mfma_f32_32x32x16_bf16 v[4:19], v[84:87], v[112:115], v[4:19]
    ds_read_b128 v[116:119], v232 offset:4096
    ds_read_b64_tr_b16 v[68:69], v228 offset:32768
    ds_read_b64_tr_b16 v[70:71], v228 offset:33792
    ds_read_b64_tr_b16 v[72:73], v229 offset:32768
    v_mfma_f32_32x32x16_bf16 v[20:35], v[88:91], v[112:115], v[20:35]
    ds_read_b64_tr_b16 v[74:75], v229 offset:33792
    ds_read_b64_tr_b16 v[76:77], v230 offset:32768
    ds_read_b64_tr_b16 v[78:79], v230 offset:33792
    ds_read_b64_tr_b16 v[80:81], v231 offset:32768
    s_add_u32 m0, s88, 16384
    s_nop 0
    s_nop 0
    buffer_load_dwordx4 v224, s[64:67], s84 offen offset:0 lds
    v_mfma_f32_32x32x16_bf16 v[36:51], v[92:95], v[112:115], v[36:51]
    ds_read_b64_tr_b16 v[82:83], v231 offset:33792
    ds_read_b128 v[120:123], v233 offset:4096
    ds_read_b128 v[124:127], v234 offset:4096
    ds_read_b128 v[128:131], v235 offset:4096
    v_mfma_f32_32x32x16_bf16 v[52:67], v[96:99], v[112:115], v[52:67]
    buffer_load_dwordx4 v225, s[64:67], s84 offen offset:1024 lds
    s_waitcnt lgkmcnt(9)
    v_mfma_f32_32x32x16_bf16 v[4:19], v[68:71], v[116:119], v[4:19]
    ds_read_b64_tr_b16 v[84:85], v228 offset:36864
    ds_read_b64_tr_b16 v[86:87], v228 offset:37888
    ds_read_b64_tr_b16 v[88:89], v229 offset:36864
    s_waitcnt lgkmcnt(10)
    v_mfma_f32_32x32x16_bf16 v[20:35], v[72:75], v[116:119], v[20:35]
    ds_read_b64_tr_b16 v[90:91], v229 offset:37888
    ds_read_b64_tr_b16 v[92:93], v230 offset:36864
    ds_read_b64_tr_b16 v[94:95], v230 offset:37888
    buffer_load_dwordx4 v226, s[64:67], s84 offen offset:2048 lds
    s_waitcnt lgkmcnt(11)
    v_mfma_f32_32x32x16_bf16 v[36:51], v[76:79], v[116:119], v[36:51]
    ds_read_b64_tr_b16 v[96:97], v231 offset:36864
    ds_read_b64_tr_b16 v[98:99], v231 offset:37888
    s_waitcnt lgkmcnt(11)
    v_mfma_f32_32x32x16_bf16 v[52:67], v[80:83], v[116:119], v[52:67]
    buffer_load_dwordx4 v227, s[64:67], s84 offen offset:3072 lds
    s_add_u32 s84, s84, 245760
    s_cmp_ge_u32 s84, s86
    s_cselect_b32 s9, 2457600, 0
    s_sub_u32 s84, s84, s9
    s_waitcnt lgkmcnt(6)
    v_mfma_f32_32x32x16_bf16 v[4:19], v[84:87], v[120:123], v[4:19]
    ds_read_b64_tr_b16 v[68:69], v228 offset:40960
    ds_read_b64_tr_b16 v[70:71], v228 offset:41984
    ds_read_b64_tr_b16 v[72:73], v229 offset:40960
    s_waitcnt lgkmcnt(7)
    v_mfma_f32_32x32x16_bf16 v[20:35], v[88:91], v[120:123], v[20:35]
    ds_read_b64_tr_b16 v[74:75], v229 offset:41984
    ds_read_b64_tr_b16 v[76:77], v230 offset:40960
    ds_read_b64_tr_b16 v[78:79], v230 offset:41984
    s_add_u32 m0, s89, 4096
    s_nop 0
    buffer_load_dwordx4 v220, s[60:63], s85 offen offset:0 lds
    s_waitcnt lgkmcnt(8)
    v_mfma_f32_32x32x16_bf16 v[36:51], v[92:95], v[120:123], v[36:51]
    ds_read_b64_tr_b16 v[80:81], v231 offset:40960
    ds_read_b64_tr_b16 v[82:83], v231 offset:41984
    s_waitcnt lgkmcnt(8)
    v_mfma_f32_32x32x16_bf16 v[52:67], v[96:99], v[120:123], v[52:67]
    buffer_load_dwordx4 v221, s[60:63], s85 offen offset:1024 lds
    s_waitcnt lgkmcnt(6)
    v_mfma_f32_32x32x16_bf16 v[4:19], v[68:71], v[124:127], v[4:19]
    ds_read_b64_tr_b16 v[84:85], v228 offset:45056
    ds_read_b64_tr_b16 v[86:87], v228 offset:46080
    ds_read_b64_tr_b16 v[88:89], v229 offset:45056
    s_waitcnt lgkmcnt(7)
    s_nop 0
    v_mfma_f32_32x32x16_bf16 v[20:35], v[72:75], v[124:127], v[20:35]
    ds_read_b64_tr_b16 v[90:91], v229 offset:46080
    ds_read_b64_tr_b16 v[92:93], v230 offset:45056
    ds_read_b64_tr_b16 v[94:95], v230 offset:46080
    buffer_load_dwordx4 v222, s[60:63], s85 offen offset:2048 lds
    s_waitcnt lgkmcnt(8)
    v_mfma_f32_32x32x16_bf16 v[36:51], v[76:79], v[124:127], v[36:51]
    ds_read_b64_tr_b16 v[96:97], v231 offset:45056
    ds_read_b64_tr_b16 v[98:99], v231 offset:46080
    s_waitcnt lgkmcnt(8)
    v_mfma_f32_32x32x16_bf16 v[52:67], v[80:83], v[124:127], v[52:67]
    buffer_load_dwordx4 v223, s[60:63], s85 offen offset:3072 lds
    s_add_u32 s85, s85, 128
    s_cmp_ge_u32 s85, s87
    s_cselect_b32 s9, 1280, 0
    s_sub_u32 s85, s85, s9
    buffer_store_dword v238, v254, s[48:51], s39 offen sc1
    s_waitcnt vmcnt(9)
    s_waitcnt lgkmcnt(0)
    s_barrier
    s_nop 0
    v_mfma_f32_32x32x16_bf16 v[4:19], v[84:87], v[128:131], v[4:19]
    ds_read_b128 v[100:103], v232 offset:0
    ds_read_b64_tr_b16 v[68:69], v228 offset:0
    ds_read_b64_tr_b16 v[70:71], v228 offset:1024
    ds_read_b64_tr_b16 v[72:73], v229 offset:0
    v_mfma_f32_32x32x16_bf16 v[20:35], v[88:91], v[128:131], v[20:35]
    ds_read_b64_tr_b16 v[74:75], v229 offset:1024
    ds_read_b64_tr_b16 v[76:77], v230 offset:0
    ds_read_b64_tr_b16 v[78:79], v230 offset:1024
    ds_read_b64_tr_b16 v[80:81], v231 offset:0
    v_mfma_f32_32x32x16_bf16 v[36:51], v[92:95], v[128:131], v[36:51]
    ds_read_b64_tr_b16 v[82:83], v231 offset:1024
    ds_read_b128 v[104:107], v233 offset:0
    ds_read_b128 v[108:111], v234 offset:0
    ds_read_b128 v[112:115], v235 offset:0
    v_mfma_f32_32x32x16_bf16 v[52:67], v[96:99], v[128:131], v[52:67]
    s_waitcnt lgkmcnt(9)
    s_nop 0
    v_mfma_f32_32x32x16_bf16 v[4:19], v[68:71], v[100:103], v[4:19]
    ds_read_b64_tr_b16 v[84:85], v228 offset:4096
    ds_read_b64_tr_b16 v[86:87], v228 offset:5120
    ds_read_b64_tr_b16 v[88:89], v229 offset:4096
    ds_read_b64_tr_b16 v[90:91], v229 offset:5120
    s_waitcnt lgkmcnt(11)
    s_nop 0
    v_mfma_f32_32x32x16_bf16 v[20:35], v[72:75], v[100:103], v[20:35]
    ds_read_b64_tr_b16 v[92:93], v230 offset:4096
    ds_read_b64_tr_b16 v[94:95], v230 offset:5120
    ds_read_b64_tr_b16 v[96:97], v231 offset:4096
    ds_read_b64_tr_b16 v[98:99], v231 offset:5120
    buffer_load_dword v255, v195, s[48:51], s45 offen sc1
    s_waitcnt lgkmcnt(13)
    v_mfma_f32_32x32x16_bf16 v[36:51], v[76:79], v[100:103], v[36:51]
    ds_write_b128 v198, v[180:183] offset:36864
    ds_write_b32 v199, v184 offset:40960
    s_waitcnt lgkmcnt(13)
    v_mfma_f32_32x32x16_bf16 v[52:67], v[80:83], v[100:103], v[52:67]
    s_waitcnt lgkmcnt(8)
    v_mfma_f32_32x32x16_bf16 v[4:19], v[84:87], v[104:107], v[4:19]
    ds_read_b64_tr_b16 v[68:69], v228 offset:8192
    ds_read_b64_tr_b16 v[70:71], v228 offset:9216
    ds_read_b64_tr_b16 v[72:73], v229 offset:8192
    s_waitcnt lgkmcnt(9)
    v_mfma_f32_32x32x16_bf16 v[20:35], v[88:91], v[104:107], v[20:35]
    ds_read_b64_tr_b16 v[74:75], v229 offset:9216
    ds_read_b64_tr_b16 v[76:77], v230 offset:8192
    ds_read_b64_tr_b16 v[78:79], v230 offset:9216
    buffer_store_dwordx4 v[212:215], v3, s[48:51], s95 offen sc1
    s_waitcnt lgkmcnt(10)
    v_mfma_f32_32x32x16_bf16 v[36:51], v[92:95], v[104:107], v[36:51]
    ds_read_b64_tr_b16 v[80:81], v231 offset:8192
    ds_read_b64_tr_b16 v[82:83], v231 offset:9216
    s_waitcnt lgkmcnt(10)
    v_mfma_f32_32x32x16_bf16 v[52:67], v[96:99], v[104:107], v[52:67]
    buffer_store_dwordx4 v[212:215], v247, s[48:51], s97 offen sc1
    s_waitcnt lgkmcnt(6)
    v_mfma_f32_32x32x16_bf16 v[4:19], v[68:71], v[108:111], v[4:19]
    ds_read_b64_tr_b16 v[84:85], v228 offset:12288
    ds_read_b64_tr_b16 v[86:87], v228 offset:13312
    ds_read_b64_tr_b16 v[88:89], v229 offset:12288
    s_waitcnt lgkmcnt(7)
    v_mfma_f32_32x32x16_bf16 v[20:35], v[72:75], v[108:111], v[20:35]
    ds_read_b64_tr_b16 v[90:91], v229 offset:13312
    ds_read_b64_tr_b16 v[92:93], v230 offset:12288
    ds_read_b64_tr_b16 v[94:95], v230 offset:13312
    buffer_store_dwordx4 v[212:215], v247, s[48:51], s97 offen offset:256 sc1
    s_waitcnt lgkmcnt(8)
    v_mfma_f32_32x32x16_bf16 v[36:51], v[76:79], v[108:111], v[36:51]
    ds_read_b64_tr_b16 v[96:97], v231 offset:12288
    ds_read_b64_tr_b16 v[98:99], v231 offset:13312
    s_waitcnt lgkmcnt(8)
    v_mfma_f32_32x32x16_bf16 v[52:67], v[80:83], v[108:111], v[52:67]
    buffer_store_dwordx4 v[212:215], v248, s[48:51], s97 offen offset:512 sc1
    s_waitcnt vmcnt(6)
    s_waitcnt lgkmcnt(0)
    s_barrier
    s_nop 0
    v_mfma_f32_32x32x16_bf16 v[4:19], v[84:87], v[112:115], v[4:19]
    ds_read_b128 v[116:119], v232 offset:4096
    ds_read_b64_tr_b16 v[68:69], v228 offset:16384
    ds_read_b64_tr_b16 v[70:71], v228 offset:17408
    ds_read_b64_tr_b16 v[72:73], v229 offset:16384
    v_mfma_f32_32x32x16_bf16 v[20:35], v[88:91], v[112:115], v[20:35]
    ds_read_b64_tr_b16 v[74:75], v229 offset:17408
    ds_read_b64_tr_b16 v[76:77], v230 offset:16384
    ds_read_b64_tr_b16 v[78:79], v230 offset:17408
    ds_read_b64_tr_b16 v[80:81], v231 offset:16384
    v_mfma_f32_32x32x16_bf16 v[36:51], v[92:95], v[112:115], v[36:51]
    ds_read_b64_tr_b16 v[82:83], v231 offset:17408
    ds_read_b128 v[120:123], v233 offset:4096
    ds_read_b128 v[124:127], v234 offset:4096
    ds_read_b128 v[128:131], v235 offset:4096
    v_mfma_f32_32x32x16_bf16 v[52:67], v[96:99], v[112:115], v[52:67]
    s_waitcnt lgkmcnt(9)
    s_nop 0
    v_mfma_f32_32x32x16_bf16 v[4:19], v[68:71], v[116:119], v[4:19]
    ds_read_b64_tr_b16 v[84:85], v228 offset:20480
    ds_read_b64_tr_b16 v[86:87], v228 offset:21504
    ds_read_b64_tr_b16 v[88:89], v229 offset:20480
    ds_read_b64_tr_b16 v[90:91], v229 offset:21504
    ds_read_b64_tr_b16 v[92:93], v230 offset:20480
    s_waitcnt lgkmcnt(12)
    s_nop 0
    v_mfma_f32_32x32x16_bf16 v[20:35], v[72:75], v[116:119], v[20:35]
    ds_read_b64_tr_b16 v[94:95], v230 offset:21504
    ds_read_b64_tr_b16 v[96:97], v231 offset:20480
    ds_read_b64_tr_b16 v[98:99], v231 offset:21504
    ds_read_b64_tr_b16 v[132:133], v196 offset:36864
    ds_read_b64_tr_b16 v[134:135], v196 offset:37024
    s_waitcnt lgkmcnt(15)
    s_nop 0
    v_mfma_f32_32x32x16_bf16 v[36:51], v[76:79], v[116:119], v[36:51]
    ds_read_b64_tr_b16 v[136:137], v196 offset:36896
    ds_read_b64_tr_b16 v[138:139], v196 offset:37056
    ds_read_b64_tr_b16 v[140:141], v196 offset:37184
    ds_read_b64_tr_b16 v[142:143], v196 offset:37344
    ds_read_b64_tr_b16 v[144:145], v196 offset:37216
    s_waitcnt lgkmcnt(15)
    v_mfma_f32_32x32x16_bf16 v[52:67], v[80:83], v[116:119], v[52:67]
    s_waitcnt lgkmcnt(13)
    v_mfma_f32_32x32x16_bf16 v[4:19], v[84:87], v[120:123], v[4:19]
    ds_read_b64_tr_b16 v[68:69], v228 offset:24576
    ds_read_b64_tr_b16 v[70:71], v228 offset:25600
    ds_read_b64_tr_b16 v[72:73], v229 offset:24576
    ds_read_b64_tr_b16 v[74:75], v229 offset:25600
    ds_read_b64_tr_b16 v[76:77], v230 offset:24576
    s_waitcnt lgkmcnt(15)
    s_nop 0
    v_mfma_f32_32x32x16_bf16 v[20:35], v[88:91], v[120:123], v[20:35]
    ds_read_b64_tr_b16 v[78:79], v230 offset:25600
    ds_read_b64_tr_b16 v[80:81], v231 offset:24576
    ds_read_b64_tr_b16 v[82:83], v231 offset:25600
    ds_read_b64_tr_b16 v[146:147], v196 offset:37376
    ds_read_b64_tr_b16 v[148:149], v196 offset:37504
    s_waitcnt lgkmcnt(15)
    s_nop 0
    v_mfma_f32_32x32x16_bf16 v[36:51], v[92:95], v[120:123], v[36:51]
    ds_read_b64_tr_b16 v[152:153], v196 offset:37536
    ds_read_b64_tr_b16 v[156:157], v197 offset:36864
    ds_read_b64_tr_b16 v[158:159], v197 offset:37024
    ds_read_b64_tr_b16 v[160:161], v197 offset:36896
    ds_read_b64_tr_b16 v[162:163], v197 offset:37056
    v_mfma_f32_32x32x16_bf16 v[52:67], v[96:99], v[120:123], v[52:67]
    s_waitcnt lgkmcnt(13)
    s_nop 0
    v_mfma_f32_32x32x16_bf16 v[4:19], v[68:71], v[124:127], v[4:19]
    ds_read_b64_tr_b16 v[84:85], v228 offset:28672
    ds_read_b64_tr_b16 v[86:87], v228 offset:29696
    ds_read_b64_tr_b16 v[88:89], v229 offset:28672
    ds_read_b64_tr_b16 v[90:91], v229 offset:29696
    ds_read_b64_tr_b16 v[92:93], v230 offset:28672
    s_waitcnt lgkmcnt(15)
    s_nop 0
    v_mfma_f32_32x32x16_bf16 v[20:35], v[72:75], v[124:127], v[20:35]
    ds_read_b64_tr_b16 v[94:95], v230 offset:29696
    ds_read_b64_tr_b16 v[96:97], v231 offset:28672
    ds_read_b64_tr_b16 v[98:99], v231 offset:29696
    ds_read_b64_tr_b16 v[164:165], v197 offset:37184
    ds_read_b64_tr_b16 v[166:167], v197 offset:37344
    s_waitcnt lgkmcnt(15)
    s_nop 0
    v_mfma_f32_32x32x16_bf16 v[36:51], v[76:79], v[124:127], v[36:51]
    ds_read_b64_tr_b16 v[168:169], v197 offset:37216
    ds_read_b64_tr_b16 v[170:171], v197 offset:37376
    ds_read_b64_tr_b16 v[172:173], v197 offset:37504
    ds_read_b64_tr_b16 v[176:177], v197 offset:37536
    v_mfma_f32_32x32x16_bf16 v[52:67], v[80:83], v[124:127], v[52:67]
    s_waitcnt lgkmcnt(12)
    v_mfma_f32_32x32x16_bf16 v[4:19], v[84:87], v[128:131], v[4:19]
    s_waitcnt lgkmcnt(10)
    v_mfma_f32_32x32x16_bf16 v[20:35], v[88:91], v[128:131], v[20:35]
    s_waitcnt lgkmcnt(8)
    v_mfma_f32_32x32x16_bf16 v[36:51], v[92:95], v[128:131], v[36:51]
    s_waitcnt lgkmcnt(6)
    v_mfma_f32_32x32x16_bf16 v[52:67], v[96:99], v[128:131], v[52:67]
    v_mov_b32 v110, 0
    v_mov_b32_e64 v111, 0
    s_nop 7
    v_cvt_pk_bf16_f32 v100, v36, v37
    v_cvt_pk_bf16_f32 v101, v38, v39
    v_cvt_pk_bf16_f32 v102, v52, v53
    v_cvt_pk_bf16_f32 v103, v54, v55
    v_cvt_pk_bf16_f32 v104, v40, v41
    v_cvt_pk_bf16_f32 v105, v42, v43
    v_cvt_pk_bf16_f32 v106, v28, v29
    v_cvt_pk_bf16_f32 v107, v30, v31
    v_cvt_pk_bf16_f32 v108, v16, v17
    v_cvt_pk_bf16_f32 v109, v18, v19
    v_mfma_f32_32x32x16_bf16 v[68:83], v[132:135], v[100:103], 0
    v_cvt_pk_bf16_f32 v112, v56, v57
    v_cvt_pk_bf16_f32 v113, v58, v59
    v_mfma_f32_32x32x16_bf16 v[84:99], v[136:139], v[100:103], 0
    v_cvt_pk_bf16_f32 v114, v60, v61
    v_cvt_pk_bf16_f32 v115, v62, v63
    v_cvt_pk_bf16_f32 v116, v44, v45
    v_mfma_f32_32x32x16_bf16 v[68:83], v[140:143], v[104:107], v[68:83]
    v_cvt_pk_bf16_f32 v117, v46, v47
    v_cvt_pk_bf16_f32 v118, v32, v33
    v_mfma_f32_32x32x16_bf16 v[84:99], v[144:147], v[104:107], v[84:99]
    v_cvt_pk_bf16_f32 v119, v34, v35
    v_cvt_pk_bf16_f32 v120, v48, v49
    v_cvt_pk_bf16_f32 v121, v50, v51
    v_mfma_f32_32x32x16_bf16 v[68:83], v[148:151], v[108:111], v[68:83]
    v_mov_b32 v122, 0x3f80
    v_mov_b32_e64 v123, 0
    v_mfma_f32_32x32x16_bf16 v[84:99], v[152:155], v[108:111], v[84:99]
    ds_write_b128 v240, v[112:115] offset:5120
    ds_write_b128 v240, v[116:119] offset:5136
    ds_write_b128 v240, v[120:123] offset:5152
    v_cvt_pk_bf16_f32 v200, v4, v5
    v_cvt_pk_bf16_f32 v201, v6, v7
    v_cvt_pk_bf16_f32 v202, v20, v21
    v_cvt_pk_bf16_f32 v203, v22, v23
    v_cvt_pk_bf16_f32 v204, v8, v9
    v_cvt_pk_bf16_f32 v205, v10, v11
    v_cvt_pk_bf16_f32 v206, v24, v25
    v_cvt_pk_bf16_f32 v207, v26, v27
    v_cvt_pk_bf16_f32 v208, v12, v13
    v_cvt_pk_bf16_f32 v209, v14, v15
    v_mov_b32 v210, 0
    v_mov_b32 v211, 0
    s_waitcnt vmcnt(4)
    v_cmp_ne_u32_e64 vcc, s83, v255
    s_cbranch_vccz L_ok_3
    s_mov_b32 s13, 0
L_spin_4:
    s_sleep 2
    buffer_load_dword v255, v195, s[48:51], s45 offen sc1
    s_add_u32 s13, s13, 1
    s_cmp_gt_u32 s13, 30000
    s_cbranch_scc1 L_ok_3
    s_waitcnt vmcnt(0)
    v_cmp_ne_u32_e64 vcc, s83, v255
    s_cbranch_vccnz L_spin_4
L_ok_3:
    v_add_u32 v240, 4096, v3
    v_max3_f32 v236, v68, v69, v70
    v_min3_f32 v237, v68, v69, v70
    v_max3_f32 v236, v236, v71, v72
    v_min3_f32 v237, v237, v71, v72
    v_max3_f32 v236, v236, v73, v74
    v_min3_f32 v237, v237, v73, v74
    v_max3_f32 v236, v236, v75, v76
    v_min3_f32 v237, v237, v75, v76
    buffer_load_dwordx4 v[4:7], v3, s[48:51], s16 offen offset:0 sc1
    v_max3_f32 v236, v236, v77, v78
    v_min3_f32 v237, v237, v77, v78
    v_max3_f32 v236, v236, v79, v80
    v_min3_f32 v237, v237, v79, v80
    v_max3_f32 v236, v236, v81, v82
    v_min3_f32 v237, v237, v81, v82
    v_max3_f32 v236, v236, v83, v84
    v_min3_f32 v237, v237, v83, v84
    buffer_load_dwordx4 v[8:11], v3, s[48:51], s16 offen offset:1024 sc1
    v_max3_f32 v236, v236, v85, v86
    v_min3_f32 v237, v237, v85, v86
    v_max_f32 v236, v236, v87
    v_min_f32 v237, v237, v87
    v_mul_f32_e64 v236, s94, v236
    v_fma_f32 v180, v68, s94, -v236
    v_fma_f32 v181, v69, s94, -v236
    v_fma_f32 v182, v70, s94, -v236
    buffer_load_dwordx4 v[12:15], v3, s[48:51], s16 offen offset:2048 sc1
    v_fma_f32 v183, v71, s94, -v236
    v_fma_f32 v184, v72, s94, -v236
    v_fma_f32 v185, v73, s94, -v236
    v_fma_f32 v186, v74, s94, -v236
    v_fma_f32 v187, v75, s94, -v236
    v_fma_f32 v188, v76, s94, -v236
    v_fma_f32 v189, v77, s94, -v236
    v_fma_f32 v190, v78, s94, -v236
    buffer_load_dwordx4 v[16:19], v3, s[48:51], s16 offen offset:3072 sc1
    v_fma_f32 v191, v79, s94, -v236
    v_fma_f32 v192, v80, s94, -v236
    v_fma_f32 v193, v81, s94, -v236
    v_fma_f32 v194, v82, s94, -v236
    v_fma_f32 v195, v83, s94, -v236
    v_fma_f32 v196, v84, s94, -v236
    v_fma_f32 v197, v85, s94, -v236
    v_fma_f32 v198, v86, s94, -v236
    buffer_load_dwordx4 v[20:23], v240, s[48:51], s16 offen offset:0 sc1
    v_fma_f32 v199, v87, s94, -v236
    v_exp_f32 v180, v180
    v_exp_f32 v181, v181
    v_exp_f32 v182, v182
    v_add_f32 v236, v180, v181
    v_exp_f32 v183, v183
    v_add_f32 v236, v236, v182
    v_exp_f32_e64 v184, v184
    buffer_load_dwordx4 v[24:27], v3, s[48:51], s17 offen offset:0 sc1
    v_add_f32 v236, v236, v183
    v_exp_f32 v185, v185
    v_add_f32 v236, v236, v184
    v_exp_f32 v186, v186
    v_add_f32 v236, v236, v185
    v_exp_f32 v187, v187
    v_add_f32 v236, v236, v186
    v_exp_f32 v188, v188
    buffer_load_dwordx4 v[28:31], v3, s[48:51], s17 offen offset:1024 sc1
    v_add_f32 v236, v236, v187
    v_exp_f32 v189, v189
    v_add_f32 v236, v236, v188
    v_exp_f32 v190, v190
    v_add_f32 v236, v236, v189
    v_exp_f32 v191, v191
    v_add_f32 v236, v236, v190
    v_exp_f32 v192, v192
    buffer_load_dwordx4 v[32:35], v3, s[48:51], s17 offen offset:2048 sc1
    v_add_f32 v236, v236, v191
    v_exp_f32 v193, v193
    v_add_f32 v236, v236, v192
    v_exp_f32 v194, v194
    v_add_f32 v236, v236, v193
    v_exp_f32 v195, v195
    v_add_f32 v236, v236, v194
    v_exp_f32 v196, v196
    buffer_load_dwordx4 v[36:39], v3, s[48:51], s17 offen offset:3072 sc1
    v_add_f32 v236, v236, v195
    v_exp_f32 v197, v197
    v_add_f32 v236, v236, v196
    v_exp_f32 v198, v198
    v_add_f32 v236, v236, v197
    v_exp_f32 v199, v199
    v_add_f32 v236, v236, v198
    v_add_f32 v236, v236, v199
    buffer_load_dwordx4 v[40:43], v240, s[48:51], s17 offen offset:0 sc1
    v_rcp_f32 v236, v236
    s_nop 0
    v_mul_f32 v180, v236, v180
    v_mul_f32 v181, v236, v181
    v_cvt_pk_bf16_f32 v112, v180, v181
    v_mul_f32 v182, v236, v182
    v_mul_f32 v183, v236, v183
    v_cvt_pk_bf16_f32 v113, v182, v183
    v_mul_f32_e64 v184, v236, v184
    buffer_load_dwordx4 v[44:47], v3, s[48:51], s18 offen offset:0 sc1
    v_mul_f32_e64 v185, v236, v185
    v_cvt_pk_bf16_f32 v114, v184, v185
    v_mul_f32 v186, v236, v186
    v_mul_f32 v187, v236, v187
    v_cvt_pk_bf16_f32 v115, v186, v187
    v_mul_f32 v188, v236, v188
    v_mul_f32 v189, v236, v189
    v_cvt_pk_bf16_f32 v116, v188, v189
    buffer_load_dwordx4 v[48:51], v3, s[48:51], s18 offen offset:1024 sc1
    v_mul_f32 v190, v236, v190
    v_mul_f32 v191, v236, v191
    v_cvt_pk_bf16_f32 v117, v190, v191
    v_mul_f32 v192, v236, v192
    v_mul_f32 v193, v236, v193
    v_cvt_pk_bf16_f32 v118, v192, v193
    v_mul_f32 v194, v236, v194
    v_mul_f32 v195, v236, v195
    buffer_load_dwordx4 v[52:55], v3, s[48:51], s18 offen offset:2048 sc1
    v_cvt_pk_bf16_f32 v119, v194, v195
    v_mul_f32 v196, v236, v196
    v_mul_f32 v197, v236, v197
    v_cvt_pk_bf16_f32 v120, v196, v197
    v_mul_f32 v198, v236, v198
    v_mul_f32 v199, v236, v199
    v_cvt_pk_bf16_f32 v121, v198, v199
    ds_write_b128 v239, v[112:115]
    buffer_load_dwordx4 v[56:59], v3, s[48:51], s18 offen offset:3072 sc1
    ds_write_b128 v239, v[116:119] offset:16
    v_mul_f32_e64 v236, s94, v237
    v_fma_f32 v68, -v68, s94, v236
    v_fma_f32 v69, -v69, s94, v236
    v_fma_f32 v70, -v70, s94, v236
    v_fma_f32 v71, -v71, s94, v236
    v_fma_f32 v72, -v72, s94, v236
    v_fma_f32 v73, -v73, s94, v236
    v_fma_f32 v74, -v74, s94, v236
    v_fma_f32 v75, -v75, s94, v236
    v_fma_f32 v76, -v76, s94, v236
    v_fma_f32 v77, -v77, s94, v236
    v_fma_f32 v78, -v78, s94, v236
    v_fma_f32 v79, -v79, s94, v236
    v_fma_f32 v80, -v80, s94, v236
    v_fma_f32 v81, -v81, s94, v236
    v_fma_f32 v82, -v82, s94, v236
    v_fma_f32 v83, -v83, s94, v236
    v_fma_f32 v84, -v84, s94, v236
    v_fma_f32 v85, -v85, s94, v236
    v_fma_f32 v86, -v86, s94, v236
    v_fma_f32 v87, -v87, s94, v236
    v_exp_f32 v68, v68
    v_exp_f32 v69, v69
    v_exp_f32 v70, v70
    v_add_f32 v236, v68, v69
    v_exp_f32 v71, v71
    v_add_f32 v236, v236, v70
    v_exp_f32 v72, v72
    v_add_f32 v236, v236, v71
    v_exp_f32 v73, v73
    v_add_f32 v236, v236, v72
    v_exp_f32 v74, v74
    v_add_f32 v236, v236, v73
    v_exp_f32 v75, v75
    v_add_f32 v236, v236, v74
    v_exp_f32 v76, v76
    v_add_f32 v236, v236, v75
    v_exp_f32 v77, v77
    v_add_f32 v236, v236, v76
    v_exp_f32 v78, v78
    v_add_f32 v236, v236, v77
    v_exp_f32 v79, v79
    v_add_f32 v236, v236, v78
    v_exp_f32 v80, v80
    v_add_f32 v236, v236, v79
    v_exp_f32 v81, v81
    v_add_f32 v236, v236, v80
    v_exp_f32 v82, v82
    v_add_f32 v236, v236, v81
    v_exp_f32 v83, v83
    v_add_f32 v236, v236, v82
    v_exp_f32 v84, v84
    v_add_f32 v236, v236, v83
    v_exp_f32 v85, v85
    v_add_f32 v236, v236, v84
    v_exp_f32 v86, v86
    v_add_f32 v236, v236, v85
    v_exp_f32 v87, v87
    v_add_f32 v236, v236, v86
    v_add_f32 v236, v236, v87
    v_rcp_f32 v236, v236
    s_nop 0
    v_mul_f32 v68, v236, v68
    v_mul_f32_e64 v69, v236, v69
    v_cvt_pk_bf16_f32 v122, v68, v69
    v_mul_f32 v70, v236, v70
    v_mul_f32 v71, v236, v71
    v_cvt_pk_bf16_f32 v123, v70, v71
    v_mul_f32 v72, v236, v72
    v_mul_f32 v73, v236, v73
    v_cvt_pk_bf16_f32 v124, v72, v73
    v_mul_f32 v74, v236, v74
    v_mul_f32 v75, v236, v75
    v_cvt_pk_bf16_f32 v125, v74, v75
    v_mul_f32 v76, v236, v76
    v_mul_f32 v77, v236, v77
    v_cvt_pk_bf16_f32 v126, v76, v77
    v_mul_f32 v78, v236, v78
    v_mul_f32 v79, v236, v79
    v_cvt_pk_bf16_f32 v127, v78, v79
    v_mul_f32 v80, v236, v80
    v_mul_f32 v81, v236, v81
    v_cvt_pk_bf16_f32 v128, v80, v81
    v_mul_f32 v82, v236, v82
    v_mul_f32 v83, v236, v83
    v_cvt_pk_bf16_f32 v129, v82, v83
    v_mul_f32 v84, v236, v84
    v_mul_f32 v85, v236, v85
    v_cvt_pk_bf16_f32 v130, v84, v85
    v_mul_f32 v86, v236, v86
    v_mul_f32 v87, v236, v87
    v_cvt_pk_bf16_f32 v131, v86, v87
    ds_write_b128 v239, v[120:123] offset:32
    ds_write_b128 v239, v[124:127] offset:48
    ds_write_b128 v239, v[128:131] offset:64
    v_lshlrev_b32_e64 v254, 9, v1
    v_mfma_f32_32x32x16_bf16 v[68:83], v[156:159], v[200:203], 0
    v_mfma_f32_32x32x16_bf16 v[84:99], v[160:163], v[200:203], 0
    s_waitcnt lgkmcnt(12)
    v_mfma_f32_32x32x16_bf16 v[68:83], v[164:167], v[204:207], v[68:83]
    s_waitcnt lgkmcnt(10)
    v_mfma_f32_32x32x16_bf16 v[84:99], v[168:171], v[204:207], v[84:99]
    s_waitcnt lgkmcnt(9)
    v_mfma_f32_32x32x16_bf16 v[68:83], v[172:175], v[208:211], v[68:83]
    s_waitcnt lgkmcnt(8)
    v_mfma_f32_32x32x16_bf16 v[84:99], v[176:179], v[208:211], v[84:99]
    s_waitcnt vmcnt(14)
    s_waitcnt lgkmcnt(0)
    s_barrier
    s_nop 0
    ds_read_b64_tr_b16 v[132:133], v241 offset:0
    ds_read_b64_tr_b16 v[134:135], v241 offset:320
    ds_read_b64_tr_b16 v[136:137], v242 offset:0
    ds_read_b64_tr_b16 v[138:139], v242 offset:192
    ds_read_b64_tr_b16 v[140:141], v241 offset:1280
    ds_read_b64_tr_b16 v[142:143], v241 offset:1600
    ds_read_b64_tr_b16 v[144:145], v242 offset:768
    ds_read_b64_tr_b16 v[146:147], v242 offset:960
    ds_read_b64_tr_b16 v[148:149], v241 offset:8192
    ds_read_b64_tr_b16 v[150:151], v241 offset:8512
    ds_read_b64_tr_b16 v[152:153], v242 offset:8192
    ds_read_b64_tr_b16 v[154:155], v242 offset:8384
    s_cmp_lg_u32 s76, 3
    s_cbranch_scc1 L_nopush_5
    s_mov_b64 exec, 65535
    buffer_store_dword v238, v254, s[48:51], s47 offen sc1
    s_mov_b64 exec, -1
L_nopush_5:
    ds_read_b64_tr_b16 v[156:157], v241 offset:9472
    ds_read_b64_tr_b16 v[158:159], v241 offset:9792
    ds_read_b64_tr_b16 v[160:161], v242 offset:8960
    ds_read_b64_tr_b16 v[162:163], v242 offset:9152
    s_waitcnt lgkmcnt(12)
    v_mfma_f32_32x32x16_bf16 v[100:115], v[132:135], v[136:139], 0
    ds_read_b64_tr_b16 v[164:165], v241 offset:16384
    ds_read_b64_tr_b16 v[166:167], v241 offset:16704
    ds_read_b64_tr_b16 v[168:169], v242 offset:16384
    ds_read_b64_tr_b16 v[170:171], v242 offset:16576
    s_waitcnt lgkmcnt(12)
    s_nop 0
    v_mfma_f32_32x32x16_bf16 v[100:115], v[140:143], v[144:147], v[100:115]
    ds_read_b64_tr_b16 v[172:173], v241 offset:17664
    ds_read_b64_tr_b16 v[174:175], v241 offset:17984
    ds_read_b64_tr_b16 v[176:177], v242 offset:17152
    ds_read_b64_tr_b16 v[178:179], v242 offset:17344
    s_waitcnt lgkmcnt(12)
    s_nop 0
    v_mfma_f32_32x32x16_bf16 v[100:115], v[148:151], v[152:155], v[100:115]
    ds_read_b64_tr_b16 v[200:201], v241 offset:24576
    ds_read_b64_tr_b16 v[202:203], v241 offset:24896
    ds_read_b64_tr_b16 v[204:205], v242 offset:24576
    ds_read_b64_tr_b16 v[206:207], v242 offset:24768
    s_waitcnt lgkmcnt(12)
    s_nop 0
    v_mfma_f32_32x32x16_bf16 v[100:115], v[156:159], v[160:163], v[100:115]
    ds_read_b64_tr_b16 v[208:209], v241 offset:25856
    ds_read_b64_tr_b16 v[210:211], v241 offset:26176
    ds_read_b64_tr_b16 v[212:213], v242 offset:25344
    ds_read_b64_tr_b16 v[214:215], v242 offset:25536
    s_waitcnt lgkmcnt(12)
    v_mfma_f32_32x32x16_bf16 v[100:115], v[164:167], v[168:171], v[100:115]
    s_waitcnt lgkmcnt(8)
    v_mfma_f32_32x32x16_bf16 v[100:115], v[172:175], v[176:179], v[100:115]
    s_waitcnt lgkmcnt(4)
    v_mfma_f32_32x32x16_bf16 v[100:115], v[200:203], v[204:207], v[100:115]
    s_waitcnt lgkmcnt(0)
    v_mfma_f32_32x32x16_bf16 v[100:115], v[208:211], v[212:215], v[100:115]
    v_max3_f32 v236, v68, v69, v70
    v_min3_f32 v237, v68, v69, v70
    v_max3_f32 v236, v236, v71, v72
    v_min3_f32 v237, v237, v71, v72
    v_max3_f32 v236, v236, v73, v74
    v_min3_f32 v237, v237, v73, v74
    v_max3_f32 v236, v236, v75, v76
    v_min3_f32 v237, v237, v75, v76
    v_max3_f32 v236, v236, v77, v78
    v_min3_f32 v237, v237, v77, v78
    s_nop 1
    s_nop 0
    v_cvt_pk_bf16_f32 v116, v100, v101
    v_cvt_pk_bf16_f32 v117, v102, v103
    v_cvt_pk_bf16_f32 v118, v104, v105
    v_cvt_pk_bf16_f32 v119, v106, v107
    buffer_store_dwordx4 v[116:119], v243, s[48:51], s96 offen sc1
    v_cvt_pk_bf16_f32 v120, v108, v109
    v_cvt_pk_bf16_f32 v121, v110, v111
    v_cvt_pk_bf16_f32 v122, v112, v113
    v_cvt_pk_bf16_f32 v123, v114, v115
    buffer_store_dwordx4 v[120:123], v244, s[48:51], s96 offen sc1
    s_and_b32 s21, s77, 3
    s_lshl_b32 s21, s21, 14
    s_add_u32 s21, s21, s99
    s_nop 0
    v_max3_f32 v236, v236, v79, v80
    v_min3_f32 v237, v237, v79, v80
    v_max3_f32 v236, v236, v81, v82
    v_min3_f32 v237, v237, v81, v82
    v_max3_f32 v236, v236, v83, v84
    v_min3_f32 v237, v237, v83, v84
    v_max3_f32 v236, v236, v85, v86
    v_min3_f32 v237, v237, v85, v86
    v_max_f32 v236, v236, v87
    v_min_f32 v237, v237, v87
    v_mul_f32_e64 v236, s94, v236
    v_fma_f32 v180, v68, s94, -v236
    v_fma_f32 v181, v69, s94, -v236
    v_fma_f32 v182, v70, s94, -v236
    v_fma_f32 v183, v71, s94, -v236
    v_fma_f32 v184, v72, s94, -v236
    v_fma_f32 v185, v73, s94, -v236
    v_fma_f32 v186, v74, s94, -v236
    v_fma_f32 v187, v75, s94, -v236
    buffer_load_dwordx4 v[60:63], v240, s[48:51], s18 offen offset:0 sc1
    v_fma_f32 v188, v76, s94, -v236
    v_fma_f32 v189, v77, s94, -v236
    v_fma_f32 v190, v78, s94, -v236
    v_fma_f32 v191, v79, s94, -v236
    v_fma_f32 v192, v80, s94, -v236
    v_fma_f32 v193, v81, s94, -v236
    v_fma_f32 v194, v82, s94, -v236
    v_fma_f32 v195, v83, s94, -v236
    v_fma_f32 v196, v84, s94, -v236
    v_fma_f32 v197, v85, s94, -v236
    v_fma_f32 v198, v86, s94, -v236
    v_fma_f32 v199, v87, s94, -v236
    v_exp_f32 v180, v180
    v_exp_f32 v181, v181
    v_exp_f32 v182, v182
    v_add_f32 v236, v180, v181
    v_exp_f32 v183, v183
    v_add_f32 v236, v236, v182
    v_exp_f32_e64 v184, v184
    buffer_load_dwordx4 v[64:67], v3, s[48:51], s19 offen offset:0 sc1
    v_add_f32 v236, v236, v183
    v_exp_f32 v185, v185
    v_add_f32 v236, v236, v184
    v_exp_f32 v186, v186
    v_add_f32 v236, v236, v185
    v_exp_f32 v187, v187
    v_add_f32 v236, v236, v186
    v_exp_f32 v188, v188
    v_add_f32 v236, v236, v187
    v_exp_f32 v189, v189
    v_add_f32 v236, v236, v188
    v_exp_f32 v190, v190
    v_add_f32 v236, v236, v189
    v_exp_f32 v191, v191
    v_add_f32 v236, v236, v190
    v_exp_f32 v192, v192
    v_add_f32 v236, v236, v191
    v_exp_f32 v193, v193
    v_add_f32_e64 v236, v236, v192
    buffer_load_dwordx4 v[220:223], v3, s[48:51], s19 offen offset:1024 sc1
    v_exp_f32 v194, v194
    v_add_f32 v236, v236, v193
    v_exp_f32 v195, v195
    v_add_f32 v236, v236, v194
    v_exp_f32 v196, v196
    v_add_f32 v236, v236, v195
    v_exp_f32 v197, v197
    v_add_f32 v236, v236, v196
    v_exp_f32 v198, v198
    v_add_f32 v236, v236, v197
    v_exp_f32 v199, v199
    v_add_f32 v236, v236, v198
    v_add_f32 v236, v236, v199
    v_rcp_f32 v236, v236
    s_nop 0
    v_mul_f32 v180, v236, v180
    v_mul_f32_e64 v181, v236, v181
    v_cvt_pk_bf16_f32 v100, v180, v181
    v_mul_f32 v182, v236, v182
    v_mul_f32 v183, v236, v183
    buffer_load_dwordx4 v[224:227], v3, s[48:51], s19 offen offset:2048 sc1
    v_cvt_pk_bf16_f32 v101, v182, v183
    v_mul_f32 v184, v236, v184
    v_mul_f32 v185, v236, v185
    v_cvt_pk_bf16_f32 v102, v184, v185
    v_mul_f32 v186, v236, v186
    v_mul_f32 v187, v236, v187
    v_cvt_pk_bf16_f32 v103, v186, v187
    v_mul_f32 v188, v236, v188
    v_mul_f32 v189, v236, v189
    v_cvt_pk_bf16_f32 v104, v188, v189
    v_mul_f32 v190, v236, v190
    v_mul_f32 v191, v236, v191
    v_cvt_pk_bf16_f32 v105, v190, v191
    v_mul_f32 v192, v236, v192
    v_mul_f32 v193, v236, v193
    v_cvt_pk_bf16_f32 v106, v192, v193
    v_mul_f32 v194, v236, v194
    v_mul_f32 v195, v236, v195
    v_cvt_pk_bf16_f32 v107, v194, v195
    buffer_load_dwordx4 v[228:231], v3, s[48:51], s19 offen offset:3072 sc1
    v_mul_f32 v196, v236, v196
    v_mul_f32 v197, v236, v197
    v_cvt_pk_bf16_f32 v108, v196, v197
    v_mul_f32 v198, v236, v198
    v_mul_f32 v199, v236, v199
    v_cvt_pk_bf16_f32 v109, v198, v199
    v_mul_f32_e64 v236, s94, v237
    v_fma_f32 v68, -v68, s94, v236
    v_fma_f32 v69, -v69, s94, v236
    v_fma_f32 v70, -v70, s94, v236
    v_fma_f32 v71, -v71, s94, v236
    v_fma_f32 v72, -v72, s94, v236
    v_fma_f32 v73, -v73, s94, v236
    v_fma_f32 v74, -v74, s94, v236
    v_fma_f32 v75, -v75, s94, v236
    v_fma_f32 v76, -v76, s94, v236
    v_fma_f32 v77, -v77, s94, v236
    v_fma_f32 v78, -v78, s94, v236
    v_fma_f32 v79, -v79, s94, v236
    buffer_load_dwordx4 v[120:123], v240, s[48:51], s19 offen offset:0 sc1
    v_fma_f32 v80, -v80, s94, v236
    v_fma_f32 v81, -v81, s94, v236
    v_fma_f32 v82, -v82, s94, v236
    v_fma_f32 v83, -v83, s94, v236
    v_fma_f32 v84, -v84, s94, v236
    v_fma_f32 v85, -v85, s94, v236
    v_fma_f32 v86, -v86, s94, v236
    v_fma_f32 v87, -v87, s94, v236
    v_exp_f32 v68, v68
    v_exp_f32 v69, v69
    v_exp_f32 v70, v70
    v_add_f32 v236, v68, v69
    v_exp_f32 v71, v71
    v_add_f32 v236, v236, v70
    v_exp_f32 v72, v72
    v_add_f32 v236, v236, v71
    v_exp_f32 v73, v73
    v_add_f32 v236, v236, v72
    v_exp_f32_e64 v74, v74
    buffer_load_dwordx4 v[124:127], v3, s[48:51], s20 offen offset:0 sc1
    v_add_f32 v236, v236, v73
    v_exp_f32 v75, v75
    v_add_f32 v236, v236, v74
    v_exp_f32 v76, v76
    v_add_f32 v236, v236, v75
    v_exp_f32 v77, v77
    v_add_f32 v236, v236, v76
    v_exp_f32 v78, v78
    v_add_f32 v236, v236, v77
    v_exp_f32 v79, v79
    v_add_f32 v236, v236, v78
    v_exp_f32 v80, v80
    v_add_f32 v236, v236, v79
    v_exp_f32 v81, v81
    v_add_f32 v236, v236, v80
    v_exp_f32 v82, v82
    v_add_f32 v236, v236, v81
    v_exp_f32 v83, v83
    v_add_f32_e64 v236, v236, v82
    buffer_load_dwordx4 v[128:131], v3, s[48:51], s20 offen offset:1024 sc1
    s_buffer_load_dwordx4 s[60:63], s[48:51], s92 glc
    v_exp_f32 v84, v84
    v_add_f32 v236, v236, v83
    v_exp_f32 v85, v85
    v_add_f32 v236, v236, v84
    v_exp_f32 v86, v86
    v_add_f32 v236, v236, v85
    v_exp_f32 v87, v87
    v_add_f32 v236, v236, v86
    v_add_f32 v236, v236, v87
    v_rcp_f32 v236, v236
    s_nop 0
    v_mul_f32 v68, v236, v68
    v_mul_f32_e64 v69, v236, v69
    v_cvt_pk_bf16_f32 v110, v68, v69
    v_mul_f32 v70, v236, v70
    v_mul_f32 v71, v236, v71
    v_cvt_pk_bf16_f32 v111, v70, v71
    v_mul_f32 v72, v236, v72
    v_mul_f32 v73, v236, v73
    v_cvt_pk_bf16_f32 v112, v72, v73
    v_mul_f32 v74, v236, v74
    v_mul_f32 v75, v236, v75
    v_cvt_pk_bf16_f32 v113, v74, v75
    v_mul_f32 v76, v236, v76
    v_mul_f32 v77, v236, v77
    v_cvt_pk_bf16_f32 v114, v76, v77
    v_mul_f32 v78, v236, v78
    v_mul_f32 v79, v236, v79
    v_cvt_pk_bf16_f32 v115, v78, v79
    v_mul_f32 v80, v236, v80
    v_mul_f32 v81, v236, v81
    v_cvt_pk_bf16_f32 v116, v80, v81
    v_mul_f32 v82, v236, v82
    v_mul_f32 v83, v236, v83
    v_cvt_pk_bf16_f32 v117, v82, v83
    v_mul_f32 v84, v236, v84
    v_mul_f32 v85, v236, v85
    v_cvt_pk_bf16_f32 v118, v84, v85
    v_mul_f32 v86, v236, v86
    v_mul_f32 v87, v236, v87
    v_cvt_pk_bf16_f32 v119, v86, v87
    s_waitcnt lgkmcnt(0)
    s_mov_b32 s14, s83
    s_mov_b32 s15, s83
    s_xor_b64 s[8:9], s[60:61], s[14:15]
    s_xor_b64 s[60:61], s[62:63], s[14:15]
    s_or_b64 s[8:9], s[8:9], s[60:61]
    s_cbranch_scc0 L_f1ok_6
    s_waitcnt lgkmcnt(0)
    s_mov_b32 s13, 0
L_ssp_8:
    s_buffer_load_dwordx4 s[60:63], s[48:51], s92 glc
    s_add_u32 s13, s13, 1
    s_waitcnt lgkmcnt(0)
    s_cmp_gt_u32 s13, 30000
    s_cbranch_scc1 L_sok_7
    s_mov_b32 s14, s83
    s_mov_b32 s15, s83
    s_xor_b64 s[8:9], s[60:61], s[14:15]
    s_xor_b64 s[60:61], s[62:63], s[14:15]
    s_or_b64 s[8:9], s[8:9], s[60:61]
    s_cbranch_scc0 L_sok_7
    s_sleep 1
    s_branch L_ssp_8
L_sok_7:
L_f1ok_6:
    s_barrier
    s_xor_b32 s9, s21, 0
    buffer_load_dwordx4 v[132:135], v245, s[48:51], s9 offen sc1
    s_xor_b32 s9, s21, 4096
    buffer_load_dwordx4 v[136:139], v245, s[48:51], s9 offen sc1
    s_xor_b32 s9, s21, 8192
    buffer_load_dwordx4 v[140:143], v245, s[48:51], s9 offen sc1
    s_xor_b32 s9, s21, 12288
    buffer_load_dwordx4 v[144:147], v245, s[48:51], s9 offen sc1
    s_xor_b32 s9, s21, 16384
    buffer_load_dwordx4 v[148:151], v245, s[48:51], s9 offen sc1
    s_xor_b32 s9, s21, 20480
    buffer_load_dwordx4 v[152:155], v245, s[48:51], s9 offen sc1
    s_xor_b32 s9, s21, 24576
    buffer_load_dwordx4 v[156:159], v245, s[48:51], s9 offen sc1
    s_xor_b32 s9, s21, 28672
    buffer_load_dwordx4 v[160:163], v245, s[48:51], s9 offen sc1
    s_xor_b32 s9, s21, 32768
    buffer_load_dwordx4 v[164:167], v245, s[48:51], s9 offen sc1
    s_xor_b32 s9, s21, 36864
    buffer_load_dwordx4 v[168:171], v245, s[48:51], s9 offen sc1
    s_xor_b32 s9, s21, 40960
    buffer_load_dwordx4 v[172:175], v245, s[48:51], s9 offen sc1
    s_xor_b32 s9, s21, 45056
    buffer_load_dwordx4 v[176:179], v245, s[48:51], s9 offen sc1
    s_xor_b32 s9, s21, 49152
    buffer_load_dwordx4 v[200:203], v245, s[48:51], s9 offen sc1
    s_xor_b32 s9, s21, 53248
    buffer_load_dwordx4 v[204:207], v245, s[48:51], s9 offen sc1
    s_xor_b32 s9, s21, 57344
    buffer_load_dwordx4 v[208:211], v245, s[48:51], s9 offen sc1
    s_xor_b32 s9, s21, 61440
    buffer_load_dwordx4 v[212:215], v245, s[48:51], s9 offen sc1
    s_waitcnt vmcnt(15)
    v_mfma_f32_32x32x16_bf16 v[68:83], v[216:219], v[132:135], 0
    v_max3_u32 v236, v132, v133, 0
    v_max3_u32 v236, v134, v135, v236
    s_waitcnt vmcnt(14)
    v_mfma_f32_32x32x16_bf16 v[68:83], v[216:219], v[136:139], v[68:83]
    v_max3_u32 v236, v136, v137, v236
    v_max3_u32 v236, v138, v139, v236
    s_waitcnt vmcnt(13)
    v_mfma_f32_32x32x16_bf16 v[68:83], v[216:219], v[140:143], v[68:83]
    v_max3_u32 v236, v140, v141, v236
    v_max3_u32 v236, v142, v143, v236
    s_waitcnt vmcnt(12)
    v_mfma_f32_32x32x16_bf16 v[68:83], v[216:219], v[144:147], v[68:83]
    v_max3_u32 v236, v144, v145, v236
    v_max3_u32 v236, v146, v147, v236
    s_waitcnt vmcnt(11)
    v_mfma_f32_32x32x16_bf16 v[68:83], v[216:219], v[148:151], v[68:83]
    v_max3_u32 v236, v148, v149, v236
    v_max3_u32 v236, v150, v151, v236
    s_waitcnt vmcnt(10)
    v_mfma_f32_32x32x16_bf16 v[68:83], v[216:219], v[152:155], v[68:83]
    v_max3_u32 v236, v152, v153, v236
    v_max3_u32 v236, v154, v155, v236
    s_waitcnt vmcnt(9)
    v_mfma_f32_32x32x16_bf16 v[68:83], v[216:219], v[156:159], v[68:83]
    v_max3_u32 v236, v156, v157, v236
    v_max3_u32 v236, v158, v159, v236
    s_waitcnt vmcnt(8)
    v_mfma_f32_32x32x16_bf16 v[68:83], v[216:219], v[160:163], v[68:83]
    v_max3_u32 v236, v160, v161, v236
    v_max3_u32 v236, v162, v163, v236
    s_waitcnt vmcnt(7)
    v_mfma_f32_32x32x16_bf16 v[68:83], v[216:219], v[164:167], v[68:83]
    v_max3_u32 v236, v164, v165, v236
    v_max3_u32 v236, v166, v167, v236
    s_waitcnt vmcnt(6)
    v_mfma_f32_32x32x16_bf16 v[68:83], v[216:219], v[168:171], v[68:83]
    v_max3_u32 v236, v168, v169, v236
    v_max3_u32 v236, v170, v171, v236
    s_waitcnt vmcnt(5)
    v_mfma_f32_32x32x16_bf16 v[68:83], v[216:219], v[172:175], v[68:83]
    v_max3_u32 v236, v172, v173, v236
    v_max3_u32 v236, v174, v175, v236
    s_waitcnt vmcnt(4)
    v_mfma_f32_32x32x16_bf16 v[68:83], v[216:219], v[176:179], v[68:83]
    v_max3_u32 v236, v176, v177, v236
    v_max3_u32 v236, v178, v179, v236
    s_waitcnt vmcnt(3)
    v_mfma_f32_32x32x16_bf16 v[68:83], v[216:219], v[200:203], v[68:83]
    v_max3_u32 v236, v200, v201, v236
    v_max3_u32 v236, v202, v203, v236
    s_waitcnt vmcnt(2)
    v_mfma_f32_32x32x16_bf16 v[68:83], v[216:219], v[204:207], v[68:83]
    v_max3_u32 v236, v204, v205, v236
    v_max3_u32 v236, v206, v207, v236
    s_waitcnt vmcnt(1)
    v_mfma_f32_32x32x16_bf16 v[68:83], v[216:219], v[208:211], v[68:83]
    v_max3_u32 v236, v208, v209, v236
    v_max3_u32 v236, v210, v211, v236
    s_waitcnt vmcnt(0)
    v_mfma_f32_32x32x16_bf16 v[68:83], v[216:219], v[212:215], v[68:83]
    v_max3_u32 v236, v212, v213, v236
    v_max3_u32 v236, v214, v215, v236
    v_cmp_eq_u32_e64 vcc, -1, v236
    s_cbranch_vccz L_rok_9
    s_mov_b32 s13, 0
L_rsp_10:
    s_sleep 2
    s_xor_b32 s9, s21, 0
    buffer_load_dwordx4 v[132:135], v245, s[48:51], s9 offen sc1
    s_xor_b32 s9, s21, 4096
    buffer_load_dwordx4 v[136:139], v245, s[48:51], s9 offen sc1
    s_xor_b32 s9, s21, 8192
    buffer_load_dwordx4 v[140:143], v245, s[48:51], s9 offen sc1
    s_xor_b32 s9, s21, 12288
    buffer_load_dwordx4 v[144:147], v245, s[48:51], s9 offen sc1
    s_xor_b32 s9, s21, 16384
    buffer_load_dwordx4 v[148:151], v245, s[48:51], s9 offen sc1
    s_xor_b32 s9, s21, 20480
    buffer_load_dwordx4 v[152:155], v245, s[48:51], s9 offen sc1
    s_xor_b32 s9, s21, 24576
    buffer_load_dwordx4 v[156:159], v245, s[48:51], s9 offen sc1
    s_xor_b32 s9, s21, 28672
    buffer_load_dwordx4 v[160:163], v245, s[48:51], s9 offen sc1
    s_xor_b32 s9, s21, 32768
    buffer_load_dwordx4 v[164:167], v245, s[48:51], s9 offen sc1
    s_xor_b32 s9, s21, 36864
    buffer_load_dwordx4 v[168:171], v245, s[48:51], s9 offen sc1
    s_xor_b32 s9, s21, 40960
    buffer_load_dwordx4 v[172:175], v245, s[48:51], s9 offen sc1
    s_xor_b32 s9, s21, 45056
    buffer_load_dwordx4 v[176:179], v245, s[48:51], s9 offen sc1
    s_xor_b32 s9, s21, 49152
    buffer_load_dwordx4 v[200:203], v245, s[48:51], s9 offen sc1
    s_xor_b32 s9, s21, 53248
    buffer_load_dwordx4 v[204:207], v245, s[48:51], s9 offen sc1
    s_xor_b32 s9, s21, 57344
    buffer_load_dwordx4 v[208:211], v245, s[48:51], s9 offen sc1
    s_xor_b32 s9, s21, 61440
    buffer_load_dwordx4 v[212:215], v245, s[48:51], s9 offen sc1
    s_add_u32 s13, s13, 1
    s_cmp_gt_u32 s13, 30000
    s_cbranch_scc1 L_rok_9
    s_waitcnt vmcnt(0)
    s_nop 0
    v_mfma_f32_32x32x16_bf16 v[68:83], v[216:219], v[132:135], 0
    v_max3_u32 v236, v132, v133, 0
    v_max3_u32 v236, v134, v135, v236
    v_mfma_f32_32x32x16_bf16 v[68:83], v[216:219], v[136:139], v[68:83]
    v_max3_u32 v236, v136, v137, v236
    v_max3_u32 v236, v138, v139, v236
    v_mfma_f32_32x32x16_bf16 v[68:83], v[216:219], v[140:143], v[68:83]
    v_max3_u32 v236, v140, v141, v236
    v_max3_u32 v236, v142, v143, v236
    v_mfma_f32_32x32x16_bf16 v[68:83], v[216:219], v[144:147], v[68:83]
    v_max3_u32 v236, v144, v145, v236
    v_max3_u32 v236, v146, v147, v236
    v_mfma_f32_32x32x16_bf16 v[68:83], v[216:219], v[148:151], v[68:83]
    v_max3_u32 v236, v148, v149, v236
    v_max3_u32 v236, v150, v151, v236
    v_mfma_f32_32x32x16_bf16 v[68:83], v[216:219], v[152:155], v[68:83]
    v_max3_u32 v236, v152, v153, v236
    v_max3_u32 v236, v154, v155, v236
    v_mfma_f32_32x32x16_bf16 v[68:83], v[216:219], v[156:159], v[68:83]
    v_max3_u32 v236, v156, v157, v236
    v_max3_u32 v236, v158, v159, v236
    v_mfma_f32_32x32x16_bf16 v[68:83], v[216:219], v[160:163], v[68:83]
    v_max3_u32 v236, v160, v161, v236
    v_max3_u32 v236, v162, v163, v236
    v_mfma_f32_32x32x16_bf16 v[68:83], v[216:219], v[164:167], v[68:83]
    v_max3_u32 v236, v164, v165, v236
    v_max3_u32 v236, v166, v167, v236
    v_mfma_f32_32x32x16_bf16 v[68:83], v[216:219], v[168:171], v[68:83]
    v_max3_u32 v236, v168, v169, v236
    v_max3_u32 v236, v170, v171, v236
    v_mfma_f32_32x32x16_bf16 v[68:83], v[216:219], v[172:175], v[68:83]
    v_max3_u32 v236, v172, v173, v236
    v_max3_u32 v236, v174, v175, v236
    v_mfma_f32_32x32x16_bf16 v[68:83], v[216:219], v[176:179], v[68:83]
    v_max3_u32 v236, v176, v177, v236
    v_max3_u32 v236, v178, v179, v236
    v_mfma_f32_32x32x16_bf16 v[68:83], v[216:219], v[200:203], v[68:83]
    v_max3_u32 v236, v200, v201, v236
    v_max3_u32 v236, v202, v203, v236
    v_mfma_f32_32x32x16_bf16 v[68:83], v[216:219], v[204:207], v[68:83]
    v_max3_u32 v236, v204, v205, v236
    v_max3_u32 v236, v206, v207, v236
    v_mfma_f32_32x32x16_bf16 v[68:83], v[216:219], v[208:211], v[68:83]
    v_max3_u32 v236, v208, v209, v236
    v_max3_u32 v236, v210, v211, v236
    v_mfma_f32_32x32x16_bf16 v[68:83], v[216:219], v[212:215], v[68:83]
    v_max3_u32 v236, v212, v213, v236
    v_max3_u32 v236, v214, v215, v236
    v_cmp_eq_u32_e64 vcc, -1, v236
    s_cbranch_vccnz L_rsp_10
L_rok_9:
    s_nop 7
    v_cvt_pk_bf16_f32 v84, v68, v69
    v_cvt_pk_bf16_f32 v85, v70, v71
    v_cvt_pk_bf16_f32 v86, v72, v73
    v_cvt_pk_bf16_f32 v87, v74, v75
    ds_write_b128 v245, v[84:87] offset:45056
    s_waitcnt lgkmcnt(0)
    s_barrier
    ds_read_b128 v[132:135], v246 offset:256
    ds_read_b128 v[136:139], v246 offset:0
    ds_read_b128 v[140:143], v246 offset:640
    ds_read_b128 v[144:147], v246 offset:384
    ds_read_b128 v[148:151], v246 offset:1024
    ds_read_b128 v[152:155], v246 offset:768
    ds_read_b128 v[156:159], v246 offset:1408
    ds_read_b128 v[160:163], v246 offset:1152
    ds_read_b128 v[164:167], v246 offset:1792
    ds_read_b128 v[168:171], v246 offset:1536
    s_waitcnt lgkmcnt(9)
    v_mfma_f32_32x32x16_bf16 v[84:99], v[132:135], v[100:103], 0
    s_waitcnt lgkmcnt(8)
    v_mfma_f32_32x32x16_bf16 v[68:83], v[136:139], v[100:103], 0
    s_add_u32 s9, s22, 1
    s_and_b32 s9, s9, 3
    s_mul_i32 s72, s9, 20480
    s_add_u32 s72, s72, s100
    s_cmp_ge_u32 s9, 2
    s_cselect_b32 s8, 18432, 0
    s_mul_i32 s9, s9, 15360
    s_add_u32 s9, s9, s8
    v_add_u32_e64 v232, s9, v3
    s_waitcnt lgkmcnt(7)
    v_mfma_f32_32x32x16_bf16 v[84:99], v[140:143], v[104:107], v[84:99]
    s_waitcnt lgkmcnt(6)
    v_mfma_f32_32x32x16_bf16 v[68:83], v[144:147], v[104:107], v[68:83]
    s_add_u32 s9, s22, 2
    s_and_b32 s9, s9, 3
    s_mul_i32 s73, s9, 20480
    s_add_u32 s73, s73, s100
    s_cmp_ge_u32 s9, 2
    s_cselect_b32 s8, 18432, 0
    s_mul_i32 s9, s9, 15360
    s_add_u32 s9, s9, s8
    v_add_u32 v233, s9, v3
    s_waitcnt lgkmcnt(5)
    v_mfma_f32_32x32x16_bf16 v[84:99], v[148:151], v[108:111], v[84:99]
    s_waitcnt lgkmcnt(4)
    v_mfma_f32_32x32x16_bf16 v[68:83], v[152:155], v[108:111], v[68:83]
    s_add_u32 s9, s22, 3
    s_and_b32 s9, s9, 3
    s_mul_i32 s74, s9, 20480
    s_add_u32 s74, s74, s100
    s_cmp_ge_u32 s9, 2
    s_cselect_b32 s8, 18432, 0
    s_mul_i32 s9, s9, 15360
    s_add_u32 s9, s9, s8
    v_add_u32 v234, s9, v3
    s_waitcnt lgkmcnt(3)
    v_mfma_f32_32x32x16_bf16 v[84:99], v[156:159], v[112:115], v[84:99]
    s_waitcnt lgkmcnt(2)
    v_mfma_f32_32x32x16_bf16 v[68:83], v[160:163], v[112:115], v[68:83]
    s_add_u32 s9, s22, 4
    s_and_b32 s9, s9, 3
    s_mul_i32 s75, s9, 20480
    s_add_u32 s75, s75, s100
    s_cmp_ge_u32 s9, 2
    s_cselect_b32 s8, 18432, 0
    s_mul_i32 s9, s9, 15360
    s_add_u32 s9, s9, s8
    v_add_u32 v235, s9, v3
    s_waitcnt lgkmcnt(1)
    v_mfma_f32_32x32x16_bf16 v[84:99], v[164:167], v[116:119], v[84:99]
    s_waitcnt lgkmcnt(0)
    v_mfma_f32_32x32x16_bf16 v[68:83], v[168:171], v[116:119], v[68:83]
    v_add_u32 v239, s40, v3
    v_add_u32 v243, s41, v3
    v_add_u32 v244, s42, v3
    v_add_u32 v245, s43, v3
    v_add_u32 v237, s44, v3
    s_cmp_lg_u32 s90, 0
    s_cbranch_scc1 L_nopush_11
    s_mov_b64 exec, 255
    buffer_store_dword v238, v254, s[48:51], s3 offen sc1
    s_mov_b64 exec, -1
L_nopush_11:
    s_nop 0
    v_add_f32 v236, 0x358637bd, v88
    v_rcp_f32 v236, v236
    s_nop 0
    v_mul_f32 v84, v236, v84
    v_mul_f32 v85, v236, v85
    v_cvt_pk_bf16_f32 v208, v84, v85
    v_mul_f32 v86, v236, v86
    v_mul_f32 v87, v236, v87
    v_cvt_pk_bf16_f32 v209, v86, v87
    v_mul_f32 v68, v236, v68
    v_mul_f32 v69, v236, v69
    v_cvt_pk_bf16_f32 v200, v68, v69
    v_permlane32_swap_b32 v208, v210
    v_permlane32_swap_b32 v209, v211
    buffer_store_dwordx4 v[208:211], v248, s[48:51], s97 offen offset:512 sc1
    v_mul_f32 v70, v236, v70
    v_mul_f32 v71, v236, v71
    v_cvt_pk_bf16_f32 v201, v70, v71
    v_mul_f32 v72, v236, v72
    v_mul_f32 v73, v236, v73
    v_cvt_pk_bf16_f32 v202, v72, v73
    v_mul_f32 v74, v236, v74
    v_mul_f32 v75, v236, v75
    v_cvt_pk_bf16_f32 v203, v74, v75
    buffer_store_dwordx4 v[200:203], v247, s[48:51], s97 offen sc1
    v_mul_f32 v76, v236, v76
    v_mul_f32 v77, v236, v77
    v_cvt_pk_bf16_f32 v204, v76, v77
    v_mul_f32 v78, v236, v78
    v_mul_f32 v79, v236, v79
    v_cvt_pk_bf16_f32 v205, v78, v79
    v_mul_f32 v80, v236, v80
    v_mul_f32 v81, v236, v81
    v_cvt_pk_bf16_f32 v206, v80, v81
    v_mul_f32 v82, v236, v82
    v_mul_f32 v83, v236, v83
    v_cvt_pk_bf16_f32 v207, v82, v83
    buffer_store_dwordx4 v[204:207], v247, s[48:51], s97 offen offset:256 sc1
    buffer_load_dwordx4 v[180:183], v3, s[48:51], s20 offen offset:2048 sc1
    buffer_load_dwordx4 v[184:187], v3, s[48:51], s20 offen offset:3072 sc1
    buffer_load_dwordx4 v[188:191], v240, s[48:51], s20 offen offset:0 sc1
    s_waitcnt lgkmcnt(0)
    s_mov_b32 s13, 0
L_ssp_13:
    s_buffer_load_dwordx4 s[60:63], s[48:51], s98 glc
    s_add_u32 s13, s13, 1
    s_waitcnt lgkmcnt(0)
    s_cmp_gt_u32 s13, 30000
    s_cbranch_scc1 L_sok_12
    s_mov_b32 s14, s83
    s_mov_b32 s15, s83
    s_xor_b64 s[8:9], s[60:61], s[14:15]
    s_xor_b64 s[60:61], s[62:63], s[14:15]
    s_or_b64 s[8:9], s[8:9], s[60:61]
    s_cbranch_scc0 L_sok_12
    s_sleep 1
    s_branch L_ssp_13
L_sok_12:
    s_nop 0
    buffer_load_dwordx4 v[132:135], v239, s[48:51], s72 offen sc1
    buffer_load_dwordx4 v[136:139], v243, s[48:51], s72 offen sc1
    buffer_load_dwordx4 v[140:143], v244, s[48:51], s72 offen sc1
    buffer_load_dwordx4 v[144:147], v245, s[48:51], s72 offen sc1
    buffer_load_dwordx4 v[148:151], v237, s[48:51], s72 offen sc1
    buffer_load_dwordx4 v[152:155], v239, s[48:51], s73 offen sc1
    buffer_load_dwordx4 v[156:159], v243, s[48:51], s73 offen sc1
    buffer_load_dwordx4 v[160:163], v244, s[48:51], s73 offen sc1
    buffer_load_dwordx4 v[164:167], v245, s[48:51], s73 offen sc1
    buffer_load_dwordx4 v[168:171], v237, s[48:51], s73 offen sc1
    s_waitcnt vmcnt(9)
    v_max_u32 v236, v132, v133
    v_max3_u32 v236, v236, v134, v135
    s_waitcnt vmcnt(8)
    v_max3_u32 v236, v236, v136, v137
    v_max3_u32 v236, v236, v138, v139
    s_waitcnt vmcnt(7)
    v_max3_u32 v236, v236, v140, v141
    v_max3_u32 v236, v236, v142, v143
    s_waitcnt vmcnt(6)
    v_max3_u32 v236, v236, v144, v145
    v_max3_u32 v236, v236, v146, v147
    s_waitcnt vmcnt(5)
    v_max3_u32 v236, v236, v148, v149
    v_max3_u32 v236, v236, v150, v151
    v_cmp_eq_u32 vcc, -1, v236
    s_cbranch_vccz L_rok_14
    s_mov_b32 s13, 0
L_rsp_15:
    s_sleep 2
    buffer_load_dwordx4 v[132:135], v239, s[48:51], s72 offen sc1
    buffer_load_dwordx4 v[136:139], v243, s[48:51], s72 offen sc1
    buffer_load_dwordx4 v[140:143], v244, s[48:51], s72 offen sc1
    buffer_load_dwordx4 v[144:147], v245, s[48:51], s72 offen sc1
    buffer_load_dwordx4 v[148:151], v237, s[48:51], s72 offen sc1
    buffer_load_dwordx4 v[152:155], v239, s[48:51], s73 offen sc1
    buffer_load_dwordx4 v[156:159], v243, s[48:51], s73 offen sc1
    buffer_load_dwordx4 v[160:163], v244, s[48:51], s73 offen sc1
    buffer_load_dwordx4 v[164:167], v245, s[48:51], s73 offen sc1
    buffer_load_dwordx4 v[168:171], v237, s[48:51], s73 offen sc1
    buffer_load_dwordx4 v[172:175], v239, s[48:51], s74 offen sc1
    buffer_load_dwordx4 v[176:179], v243, s[48:51], s74 offen sc1
    buffer_load_dwordx4 v[68:71], v244, s[48:51], s74 offen sc1
    buffer_load_dwordx4 v[72:75], v245, s[48:51], s74 offen sc1
    buffer_load_dwordx4 v[76:79], v237, s[48:51], s74 offen sc1
    buffer_load_dwordx4 v[80:83], v239, s[48:51], s75 offen sc1
    buffer_load_dwordx4 v[84:87], v243, s[48:51], s75 offen sc1
    buffer_load_dwordx4 v[88:91], v244, s[48:51], s75 offen sc1
    buffer_load_dwordx4 v[92:95], v245, s[48:51], s75 offen sc1
    buffer_load_dwordx4 v[96:99], v237, s[48:51], s75 offen sc1
    s_add_u32 s13, s13, 1
    s_cmp_gt_u32 s13, 30000
    s_cbranch_scc1 L_rok_14
    s_waitcnt vmcnt(0)
    v_max_u32 v236, v132, v133
    v_max3_u32 v236, v236, v134, v135
    v_max3_u32 v236, v236, v136, v137
    v_max3_u32 v236, v236, v138, v139
    v_max3_u32 v236, v236, v140, v141
    v_max3_u32 v236, v236, v142, v143
    v_max3_u32 v236, v236, v144, v145
    v_max3_u32 v236, v236, v146, v147
    v_max3_u32 v236, v236, v148, v149
    v_max3_u32 v236, v236, v150, v151
    v_cmp_eq_u32 vcc, -1, v236
    s_cbranch_vccnz L_rsp_15
L_rok_14:
    v_mfma_f32_16x16x32_bf16 v[100:103], v[4:7], v[132:135], 0
    v_mfma_f32_16x16x32_bf16 v[104:107], v[8:11], v[132:135], 0
    v_mfma_f32_16x16x32_bf16 v[108:111], v[12:15], v[132:135], 0
    v_mfma_f32_16x16x32_bf16 v[112:115], v[16:19], v[132:135], 0
    v_mfma_f32_16x16x32_bf16 v[116:119], v[20:23], v[132:135], 0
    buffer_load_dwordx4 v[172:175], v239, s[48:51], s74 offen sc1
    v_mfma_f32_16x16x32_bf16 v[100:103], v[24:27], v[136:139], v[100:103]
    buffer_load_dwordx4 v[176:179], v243, s[48:51], s74 offen sc1
    v_mfma_f32_16x16x32_bf16 v[104:107], v[28:31], v[136:139], v[104:107]
    buffer_load_dwordx4 v[68:71], v244, s[48:51], s74 offen sc1
    v_mfma_f32_16x16x32_bf16 v[108:111], v[32:35], v[136:139], v[108:111]
    buffer_load_dwordx4 v[72:75], v245, s[48:51], s74 offen sc1
    v_mfma_f32_16x16x32_bf16 v[112:115], v[36:39], v[136:139], v[112:115]
    buffer_load_dwordx4 v[76:79], v237, s[48:51], s74 offen sc1
    v_mfma_f32_16x16x32_bf16 v[116:119], v[40:43], v[136:139], v[116:119]
    buffer_load_dwordx4 v[80:83], v239, s[48:51], s75 offen sc1
    v_mfma_f32_16x16x32_bf16 v[100:103], v[44:47], v[140:143], v[100:103]
    buffer_load_dwordx4 v[84:87], v243, s[48:51], s75 offen sc1
    v_mfma_f32_16x16x32_bf16 v[104:107], v[48:51], v[140:143], v[104:107]
    buffer_load_dwordx4 v[88:91], v244, s[48:51], s75 offen sc1
    v_mfma_f32_16x16x32_bf16 v[108:111], v[52:55], v[140:143], v[108:111]
    buffer_load_dwordx4 v[92:95], v245, s[48:51], s75 offen sc1
    v_mfma_f32_16x16x32_bf16 v[112:115], v[56:59], v[140:143], v[112:115]
    buffer_load_dwordx4 v[96:99], v237, s[48:51], s75 offen sc1
    v_mfma_f32_16x16x32_bf16 v[116:119], v[60:63], v[140:143], v[116:119]
    s_waitcnt vmcnt(14)
    v_max_u32 v236, v152, v153
    v_mfma_f32_16x16x32_bf16 v[100:103], v[64:67], v[144:147], v[100:103]
    v_max3_u32 v236, v236, v154, v155
    v_mfma_f32_16x16x32_bf16 v[104:107], v[220:223], v[144:147], v[104:107]
    s_waitcnt vmcnt(13)
    v_max3_u32 v236, v236, v156, v157
    v_mfma_f32_16x16x32_bf16 v[108:111], v[224:227], v[144:147], v[108:111]
    v_max3_u32 v236, v236, v158, v159
    v_mfma_f32_16x16x32_bf16 v[112:115], v[228:231], v[144:147], v[112:115]
    s_waitcnt vmcnt(12)
    v_max3_u32 v236, v236, v160, v161
    v_mfma_f32_16x16x32_bf16 v[116:119], v[120:123], v[144:147], v[116:119]
    v_max3_u32 v236, v236, v162, v163
    v_mfma_f32_16x16x32_bf16 v[100:103], v[124:127], v[148:151], v[100:103]
    s_waitcnt vmcnt(11)
    v_max3_u32 v236, v236, v164, v165
    v_mfma_f32_16x16x32_bf16 v[104:107], v[128:131], v[148:151], v[104:107]
    v_max3_u32 v236, v236, v166, v167
    v_mfma_f32_16x16x32_bf16 v[108:111], v[180:183], v[148:151], v[108:111]
    s_waitcnt vmcnt(10)
    v_max3_u32 v236, v236, v168, v169
    v_mfma_f32_16x16x32_bf16 v[112:115], v[184:187], v[148:151], v[112:115]
    v_max3_u32 v236, v236, v170, v171
    v_mfma_f32_16x16x32_bf16 v[116:119], v[188:191], v[148:151], v[116:119]
    v_cmp_eq_u32 vcc, -1, v236
    s_cbranch_vccz L_rok_16
    s_mov_b32 s13, 0
L_rsp_17:
    s_sleep 2
    buffer_load_dwordx4 v[152:155], v239, s[48:51], s73 offen sc1
    buffer_load_dwordx4 v[156:159], v243, s[48:51], s73 offen sc1
    buffer_load_dwordx4 v[160:163], v244, s[48:51], s73 offen sc1
    buffer_load_dwordx4 v[164:167], v245, s[48:51], s73 offen sc1
    buffer_load_dwordx4 v[168:171], v237, s[48:51], s73 offen sc1
    buffer_load_dwordx4 v[172:175], v239, s[48:51], s74 offen sc1
    buffer_load_dwordx4 v[176:179], v243, s[48:51], s74 offen sc1
    buffer_load_dwordx4 v[68:71], v244, s[48:51], s74 offen sc1
    buffer_load_dwordx4 v[72:75], v245, s[48:51], s74 offen sc1
    buffer_load_dwordx4 v[76:79], v237, s[48:51], s74 offen sc1
    buffer_load_dwordx4 v[80:83], v239, s[48:51], s75 offen sc1
    buffer_load_dwordx4 v[84:87], v243, s[48:51], s75 offen sc1
    buffer_load_dwordx4 v[88:91], v244, s[48:51], s75 offen sc1
    buffer_load_dwordx4 v[92:95], v245, s[48:51], s75 offen sc1
    buffer_load_dwordx4 v[96:99], v237, s[48:51], s75 offen sc1
    s_add_u32 s13, s13, 1
    s_cmp_gt_u32 s13, 30000
    s_cbranch_scc1 L_rok_16
    s_waitcnt vmcnt(0)
    v_max_u32 v236, v152, v153
    v_max3_u32 v236, v236, v154, v155
    v_max3_u32 v236, v236, v156, v157
    v_max3_u32 v236, v236, v158, v159
    v_max3_u32 v236, v236, v160, v161
    v_max3_u32 v236, v236, v162, v163
    v_max3_u32 v236, v236, v164, v165
    v_max3_u32 v236, v236, v166, v167
    v_max3_u32 v236, v236, v168, v169
    v_max3_u32 v236, v236, v170, v171
    v_cmp_eq_u32 vcc, -1, v236
    s_cbranch_vccnz L_rsp_17
L_rok_16:
    v_mfma_f32_16x16x32_bf16 v[192:195], v[4:7], v[152:155], 0
    v_mfma_f32_16x16x32_bf16 v[196:199], v[8:11], v[152:155], 0
    v_mfma_f32_16x16x32_bf16 v[200:203], v[12:15], v[152:155], 0
    v_mfma_f32_16x16x32_bf16 v[204:207], v[16:19], v[152:155], 0
    v_mfma_f32_16x16x32_bf16 v[208:211], v[20:23], v[152:155], 0
    v_mfma_f32_16x16x32_bf16 v[192:195], v[24:27], v[156:159], v[192:195]
    ds_write_b128 v232, v[100:103] offset:0
    v_mfma_f32_16x16x32_bf16 v[196:199], v[28:31], v[156:159], v[196:199]
    v_mfma_f32_16x16x32_bf16 v[200:203], v[32:35], v[156:159], v[200:203]
    ds_write_b128 v232, v[104:107] offset:1024
    v_mfma_f32_16x16x32_bf16 v[204:207], v[36:39], v[156:159], v[204:207]
    v_mfma_f32_16x16x32_bf16 v[208:211], v[40:43], v[156:159], v[208:211]
    ds_write_b128 v232, v[108:111] offset:2048
    v_mfma_f32_16x16x32_bf16 v[192:195], v[44:47], v[160:163], v[192:195]
    v_mfma_f32_16x16x32_bf16 v[196:199], v[48:51], v[160:163], v[196:199]
    ds_write_b128 v232, v[112:115] offset:3072
    v_mfma_f32_16x16x32_bf16 v[200:203], v[52:55], v[160:163], v[200:203]
    v_mfma_f32_16x16x32_bf16 v[204:207], v[56:59], v[160:163], v[204:207]
    ds_write_b128 v232, v[116:119] offset:4096
    v_mfma_f32_16x16x32_bf16 v[208:211], v[60:63], v[160:163], v[208:211]
    s_waitcnt vmcnt(9)
    v_max_u32 v236, v172, v173
    v_mfma_f32_16x16x32_bf16 v[192:195], v[64:67], v[164:167], v[192:195]
    v_max3_u32 v236, v236, v174, v175
    v_mfma_f32_16x16x32_bf16 v[196:199], v[220:223], v[164:167], v[196:199]
    s_waitcnt vmcnt(8)
    v_max3_u32 v236, v236, v176, v177
    v_mfma_f32_16x16x32_bf16 v[200:203], v[224:227], v[164:167], v[200:203]
    v_max3_u32 v236, v236, v178, v179
    v_mfma_f32_16x16x32_bf16 v[204:207], v[228:231], v[164:167], v[204:207]
    s_waitcnt vmcnt(7)
    v_max3_u32 v236, v236, v68, v69
    v_mfma_f32_16x16x32_bf16 v[208:211], v[120:123], v[164:167], v[208:211]
    v_max3_u32 v236, v236, v70, v71
    v_mfma_f32_16x16x32_bf16 v[192:195], v[124:127], v[168:171], v[192:195]
    s_waitcnt vmcnt(6)
    v_max3_u32 v236, v236, v72, v73
    v_mfma_f32_16x16x32_bf16 v[196:199], v[128:131], v[168:171], v[196:199]
    v_max3_u32 v236, v236, v74, v75
    v_mfma_f32_16x16x32_bf16 v[200:203], v[180:183], v[168:171], v[200:203]
    s_waitcnt vmcnt(5)
    v_max3_u32 v236, v236, v76, v77
    v_mfma_f32_16x16x32_bf16 v[204:207], v[184:187], v[168:171], v[204:207]
    v_max3_u32 v236, v236, v78, v79
    v_mfma_f32_16x16x32_bf16 v[208:211], v[188:191], v[168:171], v[208:211]
    v_cmp_eq_u32 vcc, -1, v236
    s_cbranch_vccz L_rok_18
    s_mov_b32 s13, 0
L_rsp_19:
    s_sleep 2
    buffer_load_dwordx4 v[172:175], v239, s[48:51], s74 offen sc1
    buffer_load_dwordx4 v[176:179], v243, s[48:51], s74 offen sc1
    buffer_load_dwordx4 v[68:71], v244, s[48:51], s74 offen sc1
    buffer_load_dwordx4 v[72:75], v245, s[48:51], s74 offen sc1
    buffer_load_dwordx4 v[76:79], v237, s[48:51], s74 offen sc1
    buffer_load_dwordx4 v[80:83], v239, s[48:51], s75 offen sc1
    buffer_load_dwordx4 v[84:87], v243, s[48:51], s75 offen sc1
    buffer_load_dwordx4 v[88:91], v244, s[48:51], s75 offen sc1
    buffer_load_dwordx4 v[92:95], v245, s[48:51], s75 offen sc1
    buffer_load_dwordx4 v[96:99], v237, s[48:51], s75 offen sc1
    s_add_u32 s13, s13, 1
    s_cmp_gt_u32 s13, 30000
    s_cbranch_scc1 L_rok_18
    s_waitcnt vmcnt(0)
    v_max_u32 v236, v172, v173
    v_max3_u32 v236, v236, v174, v175
    v_max3_u32 v236, v236, v176, v177
    v_max3_u32 v236, v236, v178, v179
    v_max3_u32 v236, v236, v68, v69
    v_max3_u32 v236, v236, v70, v71
    v_max3_u32 v236, v236, v72, v73
    v_max3_u32 v236, v236, v74, v75
    v_max3_u32 v236, v236, v76, v77
    v_max3_u32 v236, v236, v78, v79
    v_cmp_eq_u32 vcc, -1, v236
    s_cbranch_vccnz L_rsp_19
L_rok_18:
    v_mfma_f32_16x16x32_bf16 v[100:103], v[4:7], v[172:175], 0
    v_mfma_f32_16x16x32_bf16 v[104:107], v[8:11], v[172:175], 0
    v_mfma_f32_16x16x32_bf16 v[108:111], v[12:15], v[172:175], 0
    v_mfma_f32_16x16x32_bf16 v[112:115], v[16:19], v[172:175], 0
    v_mfma_f32_16x16x32_bf16 v[116:119], v[20:23], v[172:175], 0
    v_mfma_f32_16x16x32_bf16 v[100:103], v[24:27], v[176:179], v[100:103]
    ds_write_b128 v233, v[192:195] offset:5120
    v_mfma_f32_16x16x32_bf16 v[104:107], v[28:31], v[176:179], v[104:107]
    v_mfma_f32_16x16x32_bf16 v[108:111], v[32:35], v[176:179], v[108:111]
    ds_write_b128 v233, v[196:199] offset:6144
    v_mfma_f32_16x16x32_bf16 v[112:115], v[36:39], v[176:179], v[112:115]
    v_mfma_f32_16x16x32_bf16 v[116:119], v[40:43], v[176:179], v[116:119]
    ds_write_b128 v233, v[200:203] offset:7168
    v_mfma_f32_16x16x32_bf16 v[100:103], v[44:47], v[68:71], v[100:103]
    v_mfma_f32_16x16x32_bf16 v[104:107], v[48:51], v[68:71], v[104:107]
    ds_write_b128 v233, v[204:207] offset:8192
    v_mfma_f32_16x16x32_bf16 v[108:111], v[52:55], v[68:71], v[108:111]
    v_mfma_f32_16x16x32_bf16 v[112:115], v[56:59], v[68:71], v[112:115]
    ds_write_b128 v233, v[208:211] offset:9216
    v_mfma_f32_16x16x32_bf16 v[116:119], v[60:63], v[68:71], v[116:119]
    s_waitcnt vmcnt(4)
    v_max_u32 v236, v80, v81
    v_mfma_f32_16x16x32_bf16 v[100:103], v[64:67], v[72:75], v[100:103]
    v_max3_u32 v236, v236, v82, v83
    v_mfma_f32_16x16x32_bf16 v[104:107], v[220:223], v[72:75], v[104:107]
    s_waitcnt vmcnt(3)
    v_max3_u32 v236, v236, v84, v85
    v_mfma_f32_16x16x32_bf16 v[108:111], v[224:227], v[72:75], v[108:111]
    v_max3_u32 v236, v236, v86, v87
    v_mfma_f32_16x16x32_bf16 v[112:115], v[228:231], v[72:75], v[112:115]
    s_waitcnt vmcnt(2)
    v_max3_u32 v236, v236, v88, v89
    v_mfma_f32_16x16x32_bf16 v[116:119], v[120:123], v[72:75], v[116:119]
    v_max3_u32 v236, v236, v90, v91
    v_mfma_f32_16x16x32_bf16 v[100:103], v[124:127], v[76:79], v[100:103]
    s_waitcnt vmcnt(1)
    v_max3_u32 v236, v236, v92, v93
    v_mfma_f32_16x16x32_bf16 v[104:107], v[128:131], v[76:79], v[104:107]
    v_max3_u32 v236, v236, v94, v95
    v_mfma_f32_16x16x32_bf16 v[108:111], v[180:183], v[76:79], v[108:111]
    s_waitcnt vmcnt(0)
    v_max3_u32 v236, v236, v96, v97
    v_mfma_f32_16x16x32_bf16 v[112:115], v[184:187], v[76:79], v[112:115]
    v_max3_u32 v236, v236, v98, v99
    v_mfma_f32_16x16x32_bf16 v[116:119], v[188:191], v[76:79], v[116:119]
    v_cmp_eq_u32 vcc, -1, v236
    s_cbranch_vccz L_rok_20
    s_mov_b32 s13, 0
L_rsp_21:
    s_sleep 2
    buffer_load_dwordx4 v[80:83], v239, s[48:51], s75 offen sc1
    buffer_load_dwordx4 v[84:87], v243, s[48:51], s75 offen sc1
    buffer_load_dwordx4 v[88:91], v244, s[48:51], s75 offen sc1
    buffer_load_dwordx4 v[92:95], v245, s[48:51], s75 offen sc1
    buffer_load_dwordx4 v[96:99], v237, s[48:51], s75 offen sc1
    s_add_u32 s13, s13, 1
    s_cmp_gt_u32 s13, 30000
    s_cbranch_scc1 L_rok_20
    s_waitcnt vmcnt(0)
    v_max_u32 v236, v80, v81
    v_max3_u32 v236, v236, v82, v83
    v_max3_u32 v236, v236, v84, v85
    v_max3_u32 v236, v236, v86, v87
    v_max3_u32 v236, v236, v88, v89
    v_max3_u32 v236, v236, v90, v91
    v_max3_u32 v236, v236, v92, v93
    v_max3_u32 v236, v236, v94, v95
    v_max3_u32 v236, v236, v96, v97
    v_max3_u32 v236, v236, v98, v99
    v_cmp_eq_u32 vcc, -1, v236
    s_cbranch_vccnz L_rsp_21
L_rok_20:
    v_mfma_f32_16x16x32_bf16 v[192:195], v[4:7], v[80:83], 0
    v_mfma_f32_16x16x32_bf16 v[196:199], v[8:11], v[80:83], 0
    v_mfma_f32_16x16x32_bf16 v[200:203], v[12:15], v[80:83], 0
    v_mfma_f32_16x16x32_bf16 v[204:207], v[16:19], v[80:83], 0
    ds_write_b128 v234, v[100:103] offset:10240
    v_mfma_f32_16x16x32_bf16 v[208:211], v[20:23], v[80:83], 0
    ds_write_b128 v234, v[104:107] offset:11264
    v_mfma_f32_16x16x32_bf16 v[192:195], v[24:27], v[84:87], v[192:195]
    ds_write_b128 v234, v[108:111] offset:12288
    v_mfma_f32_16x16x32_bf16 v[196:199], v[28:31], v[84:87], v[196:199]
    ds_write_b128 v234, v[112:115] offset:13312
    v_mfma_f32_16x16x32_bf16 v[200:203], v[32:35], v[84:87], v[200:203]
    ds_write_b128 v234, v[116:119] offset:14336
    v_mfma_f32_16x16x32_bf16 v[204:207], v[36:39], v[84:87], v[204:207]
    v_mfma_f32_16x16x32_bf16 v[208:211], v[40:43], v[84:87], v[208:211]
    v_mfma_f32_16x16x32_bf16 v[192:195], v[44:47], v[88:91], v[192:195]
    s_waitcnt lgkmcnt(0)
    s_barrier
    ds_read_b128 v[132:135], v235 offset:0
    ds_read_b128 v[152:155], v235 offset:5120
    ds_read_b128 v[172:175], v235 offset:10240
    v_mfma_f32_16x16x32_bf16 v[196:199], v[48:51], v[88:91], v[196:199]
    ds_read_b128 v[136:139], v235 offset:1024
    v_mfma_f32_16x16x32_bf16 v[200:203], v[52:55], v[88:91], v[200:203]
    ds_read_b128 v[156:159], v235 offset:6144
    v_mfma_f32_16x16x32_bf16 v[204:207], v[56:59], v[88:91], v[204:207]
    ds_read_b128 v[176:179], v235 offset:11264
    v_mfma_f32_16x16x32_bf16 v[208:211], v[60:63], v[88:91], v[208:211]
    ds_read_b128 v[140:143], v235 offset:2048
    v_mfma_f32_16x16x32_bf16 v[192:195], v[64:67], v[92:95], v[192:195]
    ds_read_b128 v[160:163], v235 offset:7168
    v_mfma_f32_16x16x32_bf16 v[196:199], v[220:223], v[92:95], v[196:199]
    ds_read_b128 v[68:71], v235 offset:12288
    v_mfma_f32_16x16x32_bf16 v[200:203], v[224:227], v[92:95], v[200:203]
    ds_read_b128 v[144:147], v235 offset:3072
    v_mfma_f32_16x16x32_bf16 v[204:207], v[228:231], v[92:95], v[204:207]
    ds_read_b128 v[164:167], v235 offset:8192
    v_mfma_f32_16x16x32_bf16 v[208:211], v[120:123], v[92:95], v[208:211]
    ds_read_b128 v[72:75], v235 offset:13312
    v_mfma_f32_16x16x32_bf16 v[192:195], v[124:127], v[96:99], v[192:195]
    ds_read_b128 v[148:151], v235 offset:4096
    v_mfma_f32_16x16x32_bf16 v[196:199], v[128:131], v[96:99], v[196:199]
    ds_read_b128 v[168:171], v235 offset:9216
    v_mfma_f32_16x16x32_bf16 v[200:203], v[180:183], v[96:99], v[200:203]
    ds_read_b128 v[76:79], v235 offset:14336
    v_mfma_f32_16x16x32_bf16 v[204:207], v[184:187], v[96:99], v[204:207]
    v_mfma_f32_16x16x32_bf16 v[208:211], v[188:191], v[96:99], v[208:211]
    s_waitcnt lgkmcnt(13)
    v_add_f32 v132, v132, v152
    v_add_f32 v133, v133, v153
    v_add_f32 v134, v134, v154
    v_add_f32 v135, v135, v155
    s_waitcnt lgkmcnt(10)
    v_add_f32 v136, v136, v156
    v_add_f32 v137, v137, v157
    v_add_f32 v138, v138, v158
    v_add_f32_e64 v139, v139, v159
    s_waitcnt lgkmcnt(7)
    v_pk_add_f32 v[140:141], v[140:141], v[160:161]
    v_pk_add_f32 v[142:143], v[142:143], v[162:163]
    s_waitcnt lgkmcnt(4)
    v_pk_add_f32 v[144:145], v[144:145], v[164:165]
    v_pk_add_f32 v[146:147], v[146:147], v[166:167]
    s_waitcnt lgkmcnt(1)
    v_pk_add_f32 v[148:149], v[148:149], v[168:169]
    v_pk_add_f32 v[150:151], v[150:151], v[170:171]
    v_pk_add_f32 v[192:193], v[192:193], v[172:173]
    v_pk_add_f32 v[192:193], v[192:193], v[132:133]
    v_pk_add_f32 v[194:195], v[194:195], v[174:175]
    v_pk_add_f32 v[194:195], v[194:195], v[134:135]
    v_cvt_pk_bf16_f32 v4, v192, v193
    v_cvt_pk_bf16_f32 v5, v194, v195
    v_pk_add_f32 v[196:197], v[196:197], v[176:177]
    v_pk_add_f32 v[196:197], v[196:197], v[136:137]
    v_pk_add_f32 v[198:199], v[198:199], v[178:179]
    v_pk_add_f32 v[198:199], v[198:199], v[138:139]
    v_cvt_pk_bf16_f32 v6, v196, v197
    v_cvt_pk_bf16_f32 v7, v198, v199
    v_pk_add_f32 v[200:201], v[200:201], v[68:69]
    v_pk_add_f32 v[200:201], v[200:201], v[140:141]
    v_pk_add_f32 v[202:203], v[202:203], v[70:71]
    v_pk_add_f32 v[202:203], v[202:203], v[142:143]
    v_cvt_pk_bf16_f32 v8, v200, v201
    v_cvt_pk_bf16_f32 v9, v202, v203
    v_pk_add_f32 v[204:205], v[204:205], v[72:73]
    v_pk_add_f32 v[204:205], v[204:205], v[144:145]
    v_pk_add_f32 v[206:207], v[206:207], v[74:75]
    v_pk_add_f32 v[206:207], v[206:207], v[146:147]
    v_cvt_pk_bf16_f32 v10, v204, v205
    v_cvt_pk_bf16_f32 v11, v206, v207
    s_waitcnt lgkmcnt(0)
    s_nop 0
    v_pk_add_f32 v[208:209], v[208:209], v[76:77]
    v_pk_add_f32 v[208:209], v[208:209], v[148:149]
    v_pk_add_f32 v[210:211], v[210:211], v[78:79]
    v_pk_add_f32 v[210:211], v[210:211], v[150:151]
    v_cvt_pk_bf16_f32 v12, v208, v209
    v_cvt_pk_bf16_f32 v13, v210, v211
    v_add_u32_e64 v239, s93, v3
    ds_write_b64 v250, v[4:5] offset:0
    ds_write_b64 v250, v[6:7] offset:8
    ds_write_b64 v250, v[8:9] offset:16
    ds_write_b64 v250, v[10:11] offset:24
    ds_write_b64 v250, v[12:13] offset:32
    ds_read_b128 v[16:19], v239 offset:30720
    ds_read_b128 v[20:23], v239 offset:31744
    ds_read_b128 v[24:27], v239 offset:32768
    s_waitcnt lgkmcnt(2)
    buffer_store_dwordx4 v[16:19], v251, s[52:55], s46 offen
    s_waitcnt lgkmcnt(1)
    buffer_store_dwordx4 v[20:23], v252, s[52:55], s46 offen
    s_mov_b32 exec_hi, 0
    s_waitcnt lgkmcnt(0)
    buffer_store_dwordx4 v[24:27], v253, s[52:55], s46 offen
    s_mov_b64 exec, -1
    s_endpgm
L_B:
    v_and_b32 v1, 63, v0
    v_lshrrev_b32 v4, 6, v0
    v_lshrrev_b32 v2, 4, v1
    v_readfirstlane_b32 s76, v4
    v_and_b32_e64 v3, 15, v1
    s_mul_hi_u32 s79, s77, 0x33333334
    s_mul_i32 s4, s79, 5
    s_sub_u32 s80, s77, s4
    v_mul_u32_u24 v220, 1280, v2
    v_lshl_add_u32 v220, v3, 4, v220
    s_lshl_b32 s4, s79, 2
    s_add_u32 s4, s4, s76
    s_mul_i32 s73, s4, 40960
    s_mul_i32 s4, s4, 20480
    s_lshl_b32 s5, s80, 8
    s_add_u32 s74, s4, s5
    s_add_u32 s73, s73, s5
    s_add_u32 s73, s73, 1280
    s_lshl_b32 s64, s76, 12
    s_add_u32 s64, s64, 2048
    s_mov_b32 s60, s24
    s_and_b32 s61, s25, 0xffff
    s_mov_b32 s62, 2621440
    s_mov_b32 s63, 0x00020000
    s_mov_b32 s56, s44
    s_and_b32 s57, s45, 0xffff
    s_mov_b32 s58, 256
    s_mov_b32 s59, 0x00020000
    s_or_b32 s4, s77, s76
    s_cbranch_scc1 L_nonce_22
    s_or_b32 s10, s10, 1
    v_mov_b32_e64 v4, s10
    s_mov_b64 exec, 1
    buffer_store_dword v4, off, s[56:59], 0 offset:4 sc1
    s_mov_b64 exec, -1
L_nonce_22:
    s_mov_b32 s48, s46
    s_and_b32 s49, s47, 0xffff
    s_mov_b32 s50, 16777216
    s_mov_b32 s51, 0x00020000
    s_mov_b32 s52, s42
    s_and_b32 s53, s43, 0xffff
    s_mov_b32 s54, 5242880
    s_mov_b32 s55, 0x00020000
    s_setprio 0
    s_mul_i32 s81, s76, 11440
    s_add_u32 s81, s81, 30720
    s_mul_i32 s82, s76, 3072
    s_add_u32 s82, s82, 18432
    v_lshlrev_b32 v246, 4, v1
    v_mov_b32 v144, 0
    v_mov_b32 v145, 0
    v_mov_b32 v146, 0
    v_mov_b32 v147, 0
    v_lshlrev_b32 v4, 3, v0
    ds_write_b64 v4, v[144:145]
    v_min_u32_e64 v4, 42, v1
    v_lshl_add_u32 v4, v4, 4, s82
    v_cmp_lt_u32_e64 vcc, 1, v1
    v_add_u32 v5, 720, v4
    s_nop 0
    v_cndmask_b32 v4, v4, v5, vcc
    v_cmp_lt_u32_e64 vcc, 4, v1
    v_add_u32 v5, 512, v4
    s_nop 0
    v_cndmask_b32 v4, v4, v5, vcc
    v_cmp_lt_u32_e64 vcc, 40, v1
    v_add_u32 v5, 240, v4
    s_nop 0
    v_cndmask_b32 v4, v4, v5, vcc
    ds_write_b128 v4, v[144:147]
    v_lshlrev_b32 v4, 3, v2
    v_sub_u32 v11, v3, v4
    v_add_u32 v11, 33, v11
    v_cvt_f32_u32 v10, v11
    s_mov_b32 s7, 0x0202
    s_mov_b32 s8, 0x10001
    v_mov_b32 v9, 0x01000100
    v_add_f32 v4, 0x43090000, v10
    v_add_f32 v5, 0x43080000, v10
    v_cvt_pk_bf16_f32 v221, v4, v5
    v_lshrrev_b32 v7, 17, v221
    v_lshlrev_b32 v7, 1, v7
    v_mul_u32_u24 v6, s8, v7
    v_and_b32 v222, -2, v11
    v_lshl_add_u32 v222, v222, 1, s82
    v_subrev_u32 v222, 16, v222
    v_sub_u32 v221, v221, v6
    v_mad_u32_u24 v221, v221, s7, v9
    v_add_f32 v4, 0x43848000, v10
    v_add_f32 v5, 0x43840000, v10
    v_cvt_pk_bf16_f32 v223, v4, v5
    v_lshrrev_b32 v7, 17, v223
    v_lshlrev_b32 v7, 1, v7
    v_mul_u32_u24_e64 v6, s8, v7
    v_lshl_add_u32 v224, v7, 1, s82
    v_subrev_u32 v224, 33760, v224
    v_sub_u32_e64 v223, v223, v6
    v_mad_u32_u24 v223, v223, s7, v9
    v_add_f32 v4, 0x43858000, v10
    v_add_f32 v5, 0x43850000, v10
    v_cvt_pk_bf16_f32 v225, v4, v5
    v_sub_u32_e64 v225, v225, v6
    v_mad_u32_u24 v225, v225, s7, v9
    v_sub_u32 v226, 67241990, v221
    v_subrev_u32 v4, 9, v11
    v_min_u32_e64 v4, 31, v4
    s_movk_i32 s7, 0x3f80
    s_mov_b32 s8, 16744448
    v_lshrrev_b32 v5, v4, s8
    v_bfe_u32 v6, v5, 7, 1
    v_bfe_u32 v7, v5, 6, 1
    v_lshl_or_b32 v6, v7, 16, v6
    v_mul_u32_u24_e64 v204, s7, v6
    v_bfe_u32 v6, v5, 5, 1
    v_bfe_u32 v7, v5, 4, 1
    v_lshl_or_b32 v6, v7, 16, v6
    v_mul_u32_u24_e64 v205, s7, v6
    v_bfe_u32 v6, v5, 3, 1
    v_bfe_u32 v7, v5, 2, 1
    v_lshl_or_b32 v6, v7, 16, v6
    v_mul_u32_u24_e64 v206, s7, v6
    v_bfe_u32 v6, v5, 1, 1
    v_bfe_u32 v7, v5, 0, 1
    v_lshl_or_b32 v6, v7, 16, v6
    v_mul_u32_u24_e64 v207, s7, v6
    s_mov_b32 s8, 8323072
    v_lshrrev_b32 v5, v4, s8
    v_bfe_u32 v6, v5, 7, 1
    v_bfe_u32 v7, v5, 6, 1
    v_lshl_or_b32 v6, v7, 16, v6
    v_mul_u32_u24_e64 v208, s7, v6
    v_bfe_u32 v6, v5, 5, 1
    v_bfe_u32 v7, v5, 4, 1
    v_lshl_or_b32 v6, v7, 16, v6
    v_mul_u32_u24_e64 v209, s7, v6
    v_bfe_u32 v6, v5, 3, 1
    v_bfe_u32 v7, v5, 2, 1
    v_lshl_or_b32 v6, v7, 16, v6
    v_mul_u32_u24_e64 v210, s7, v6
    v_bfe_u32 v6, v5, 1, 1
    v_bfe_u32 v7, v5, 0, 1
    v_lshl_or_b32 v6, v7, 16, v6
    v_mul_u32_u24_e64 v211, s7, v6
    s_mov_b32 s8, 4063232
    v_lshrrev_b32 v5, v4, s8
    v_bfe_u32 v6, v5, 7, 1
    v_bfe_u32 v7, v5, 6, 1
    v_lshl_or_b32 v6, v7, 16, v6
    v_mul_u32_u24_e64 v212, s7, v6
    v_bfe_u32 v6, v5, 5, 1
    v_bfe_u32 v7, v5, 4, 1
    v_lshl_or_b32 v6, v7, 16, v6
    v_mul_u32_u24_e64 v213, s7, v6
    v_bfe_u32 v6, v5, 3, 1
    v_bfe_u32 v7, v5, 2, 1
    v_lshl_or_b32 v6, v7, 16, v6
    v_mul_u32_u24_e64 v214, s7, v6
    v_bfe_u32 v6, v5, 1, 1
    v_bfe_u32 v7, v5, 0, 1
    v_lshl_or_b32 v6, v7, 16, v6
    v_mul_u32_u24_e64 v215, s7, v6
    s_mov_b32 s8, 1835008
    v_lshrrev_b32 v5, v4, s8
    v_bfe_u32 v6, v5, 7, 1
    v_bfe_u32 v7, v5, 6, 1
    v_lshl_or_b32 v6, v7, 16, v6
    v_mul_u32_u24_e64 v216, s7, v6
    v_bfe_u32 v6, v5, 5, 1
    v_bfe_u32 v7, v5, 4, 1
    v_lshl_or_b32 v6, v7, 16, v6
    v_mul_u32_u24_e64 v217, s7, v6
    v_bfe_u32 v6, v5, 3, 1
    v_bfe_u32 v7, v5, 2, 1
    v_lshl_or_b32 v6, v7, 16, v6
    v_mul_u32_u24_e64 v218, s7, v6
    v_bfe_u32 v6, v5, 1, 1
    v_bfe_u32 v7, v5, 0, 1
    v_lshl_or_b32 v6, v7, 16, v6
    v_mul_u32_u24 v219, s7, v6
    v_and_b32 v4, 1, v2
    v_lshrrev_b32 v5, 1, v2
    v_lshlrev_b32 v6, 3, v4
    v_sub_u32_e64 v227, v3, v6
    v_add_u32 v227, 938, v227
    v_and_b32_e64 v227, -2, v227
    v_mul_u32_u24 v6, 136, v5
    v_add_u32_e64 v227, v227, v6
    v_lshl_add_u32 v227, v227, 1, s82
    v_lshlrev_b32 v6, 1, v5
    v_sub_u32 v6, v3, v6
    v_add_u32 v6, 13, v6
    v_lshrrev_b32 v7, 4, v6
    v_add_lshl_u32 v247, v6, v7, 3
    v_mul_u32_u24 v6, 272, v4
    v_mul_u32_u24 v7, 2312, v5
    v_add3_u32 v247, v247, v6, v7
    v_add_u32_e64 v247, s81, v247
    v_add_u32 v228, 658, v3
    v_and_b32_e64 v228, -2, v228
    v_mul_u32_u24 v6, 68, v2
    v_add_u32_e64 v228, v228, v6
    v_lshl_add_u32 v228, v228, 1, s82
    v_sub_u32 v6, v3, v2
    v_add_u32 v6, 13, v6
    v_lshrrev_b32_e64 v7, 4, v6
    v_add_lshl_u32 v249, v6, v7, 3
    v_mul_u32_u24 v6, 3400, v4
    v_add3_u32 v249, v249, v6, s81
    v_lshl_add_u32 v6, v3, 2, v2
    v_lshrrev_b32_e64 v7, 2, v3
    v_add_lshl_u32 v248, v6, v7, 3
    v_add_u32 v248, s81, v248
    v_lshlrev_b32 v4, 1, v1
    v_add_u32 v5, 256, v4
    v_add_u32 v6, 464, v4
    v_cmp_lt_u32 vcc, 15, v1
    s_nop 1
    v_cndmask_b32_e64 v5, v5, v6, vcc
    v_add_u32 v6, 928, v4
    v_cmp_lt_u32 vcc, 39, v1
    s_nop 1
    v_cndmask_b32_e64 v5, v5, v6, vcc
    s_sub_u32 s4, s82, 33760
    v_cvt_f32_u32_e64 v6, v5
    v_subrev_u32 v7, 1027, v5
    v_cvt_pk_bf16_f32 v6, v6, 0
    v_lshl_add_u32 v6, v6, 1, s4
    v_cmp_lt_u32 vcc, 517, v5
    v_add_u32 v8, 4, v6
    s_nop 0
    v_cndmask_b32_e64 v6, v6, v8, vcc
    v_cmp_gt_u32 vcc, 526, v5
    v_mov_b32 v229, s82
    s_nop 0
    v_cndmask_b32 v6, v229, v6, vcc
    v_cmp_gt_u32 vcc, 9, v7
    v_add_u32 v8, 2160, v229
    s_nop 0
    v_cndmask_b32 v6, v6, v8, vcc
    v_cmp_gt_u32_e64 vcc, 2, v7
    v_add_u32 v8, 1888, v229
    s_nop 0
    v_cndmask_b32 v229, v6, v8, vcc
    v_add_u32 v5, 1, v5
    v_cvt_f32_u32 v6, v5
    v_subrev_u32 v7, 1027, v5
    v_cvt_pk_bf16_f32 v6, v6, 0
    v_lshl_add_u32 v6, v6, 1, s4
    v_cmp_lt_u32 vcc, 517, v5
    v_add_u32 v8, 4, v6
    s_nop 0
    v_cndmask_b32_e64 v6, v6, v8, vcc
    v_cmp_gt_u32 vcc, 526, v5
    v_mov_b32 v230, s82
    s_nop 0
    v_cndmask_b32 v6, v230, v6, vcc
    v_cmp_gt_u32 vcc, 9, v7
    v_add_u32 v8, 2160, v230
    s_nop 0
    v_cndmask_b32 v6, v6, v8, vcc
    v_cmp_gt_u32_e64 vcc, 2, v7
    v_add_u32 v8, 1888, v230
    s_nop 0
    v_cndmask_b32 v230, v6, v8, vcc
    v_lshl_add_u32 v231, v1, 2, s82
    s_add_u32 s5, s82, 1346
    v_writelane_b32 v230, s5, 57
    s_add_u32 s5, s82, 800
    v_writelane_b32 v231, s5, 57
    s_add_u32 s5, s82, 1482
    v_writelane_b32 v230, s5, 58
    s_add_u32 s5, s82, 936
    v_writelane_b32 v231, s5, 58
    s_add_u32 s5, s82, 1618
    v_writelane_b32 v230, s5, 59
    s_add_u32 s5, s82, 1072
    v_writelane_b32 v231, s5, 59
    s_add_u32 s5, s82, 1754
    v_writelane_b32 v230, s5, 60
    s_add_u32 s5, s82, 1208
    v_writelane_b32 v231, s5, 60
    s_add_u32 s5, s82, 1890
    v_writelane_b32 v230, s5, 61
    s_add_u32 s5, s82, 1344
    v_writelane_b32 v231, s5, 61
    s_add_u32 s5, s82, 2162
    v_writelane_b32 v230, s5, 62
    s_add_u32 s5, s82, 1616
    v_writelane_b32 v231, s5, 62
    s_add_u32 s5, s82, 1888
    v_writelane_b32 v229, s5, 63
    s_add_u32 s5, s82, 864
    v_writelane_b32 v231, s5, 63
    v_lshlrev_b32_e64 v4, 4, v3
    v_lshl_add_u32 v4, v2, 3, v4
    v_lshlrev_b32_e64 v5, 3, v3
    v_lshl_add_u32 v5, v2, 8, v5
    v_cmp_lt_u32 vcc, 1, v2
    v_add_u32 v6, 32, v4
    v_add_u32 v7, 288, v5
    v_cndmask_b32 v6, v6, v7, vcc
    v_add_u32 v232, s82, v6
    v_add_u32 v6, 288, v4
    v_add_u32 v7, 416, v5
    v_cndmask_b32 v6, v6, v7, vcc
    v_add_u32 v233, s82, v6
    v_and_b32 v4, 1, v3
    v_mul_u32_u24 v4, 60, v4
    v_lshl_add_u32 v4, v3, 3, v4
    v_add_u32 v4, 672, v4
    v_lshlrev_b32_e64 v5, 4, v3
    v_min_u32 v5, 152, v5
    v_add_u32 v5, 880, v5
    v_cmp_lt_u32 vcc, 3, v3
    s_nop 1
    v_cndmask_b32_e64 v4, v4, v5, vcc
    v_lshl_add_u32 v4, v2, 1, v4
    v_lshl_add_u32 v234, v4, 1, s82
    v_and_b32 v4, 1, v2
    v_lshrrev_b32 v5, 1, v2
    v_lshrrev_b32 v6, 2, v3
    v_and_b32 v7, 3, v3
    v_lshl_add_u32 v235, v4, 3, v6
    v_lshlrev_b32_e64 v235, 8, v235
    v_lshl_add_u32 v235, v5, 5, v235
    v_lshl_add_u32 v235, v7, 3, v235
    v_add_u32 v235, s64, v235
    s_lshl_b32 s4, s79, 1
    s_lshr_b32 s5, s76, 1
    s_add_u32 s4, s4, s5
    v_add_u32 v7, s4, v7
    v_and_b32 v7, 3, v7
    v_lshl_add_u32 v236, v5, 2, v6
    v_lshlrev_b32_e64 v236, 14, v236
    v_lshl_add_u32 v236, v4, 6, v236
    v_lshl_add_u32 v236, v7, 4, v236
    s_lshl_b32 s65, s80, 19
    s_lshl_b32 s5, s79, 9
    s_add_u32 s65, s65, s5
    s_lshl_b32 s5, s76, 7
    s_add_u32 s65, s65, s5
    s_add_u32 s72, s65, 2621440
    s_lshl_b32 s66, s80, 14
    s_lshl_b32 s5, s79, 9
    s_add_u32 s69, s66, s5
    s_add_u32 s69, s69, 9895936
    s_lshr_b32 s5, s79, 3
    s_lshl_b32 s5, s5, 7
    s_add_u32 s66, s66, s5
    s_and_b32 s5, s79, 7
    s_lshl_b32 s5, s5, 2
    s_add_u32 s66, s66, s5
    s_add_u32 s66, s66, 9764864
    s_lshl_b32 s67, s77, 9
    s_add_u32 s67, s67, 9764864
    s_lshr_b32 s68, s77, 5
    s_lshl_b32 s68, s68, 14
    s_and_b32 s4, s77, 31
    s_lshr_b32 s5, s4, 3
    s_lshl_b32 s5, s5, 7
    s_add_u32 s68, s68, s5
    s_and_b32 s5, s4, 7
    s_lshl_b32 s5, s5, 2
    s_add_u32 s68, s68, s5
    s_add_u32 s68, s68, 9895936
    s_lshl_b32 s5, s76, 7
    s_add_u32 s67, s67, s5
    s_add_u32 s69, s69, s5
    s_lshl_b32 s70, s77, 14
    s_lshl_b32 s5, s76, 12
    s_add_u32 s70, s70, s5
    s_add_u32 s71, s70, 2621440
    v_lshlrev_b32_e64 v250, 9, v1
    s_buffer_load_dword s93, s[48:51], s67 glc
    s_buffer_load_dword s93, s[48:51], s69 glc
    v_add_u32 v237, s81, v246
    v_lshrrev_b32 v4, 1, v3
    v_mul_u32_u24 v238, 1040, v4
    v_and_b32_e64 v4, 1, v3
    v_lshl_add_u32 v238, v4, 3, v238
    v_lshl_add_u32 v238, v2, 5, v238
    v_add_u32_e64 v238, s81, v238
    v_add_u32 v239, 6240, v238
    v_lshl_add_u32 v4, v3, 1, v2
    v_add_u32 v5, 14, v4
    v_lshrrev_b32 v6, 2, v5
    v_add_u32 v6, s76, v6
    v_and_b32 v6, 3, v6
    v_lshlrev_b32_e64 v5, 6, v5
    v_lshl_add_u32 v251, v6, 4, v5
    v_add_u32 v5, 10, v4
    v_lshrrev_b32 v6, 2, v5
    v_add_u32 v6, s76, v6
    v_and_b32 v6, 3, v6
    v_lshlrev_b32_e64 v5, 6, v5
    v_lshl_add_u32 v252, v6, 4, v5
    v_add_u32 v5, 6, v4
    v_lshrrev_b32 v6, 2, v5
    v_add_u32 v6, s76, v6
    v_and_b32 v6, 3, v6
    v_lshlrev_b32_e64 v5, 6, v5
    v_lshl_add_u32 v253, v6, 4, v5
    v_add_u32 v5, 2, v4
    v_lshrrev_b32 v6, 2, v5
    v_add_u32 v6, s76, v6
    v_and_b32 v6, 3, v6
    v_lshlrev_b32_e64 v5, 6, v5
    v_lshl_add_u32 v254, v6, 4, v5
    s_mov_b32 s7, 0x3fb8aa3b
    s_mov_b32 s8, 0x3e22f983
    s_lshl_b32 s4, s76, 4
    s_waitcnt lgkmcnt(0)
    s_lshr_b64 s[100:101], s[100:101], s4
    s_lshr_b64 s[16:17], s[16:17], s4
    s_lshl_b32 s100, s100, 16
    s_lshl_b32 s101, s16, 16
    v_mov_b32 v4, s100
    v_mul_f32_e64 v5, s7, v4
    v_fma_f32 v6, v4, s7, -v5
    v_fmac_f32 v6, 0x32a57060, v4
    v_exp_f32_e64 v5, v5
    v_mul_f32 v6, 0x3f317218, v6
    v_fma_f32 v5, v5, v6, v5
    v_cvt_pk_bf16_f32 v5, v5, v5
    v_and_b32 v8, 0xffff0000, v5
    s_waitcnt vmcnt(5)
    v_lshlrev_b32 v112, 16, v136
    v_and_b32 v124, 0xffff0000, v136
    s_waitcnt vmcnt(4)
    v_lshlrev_b32 v113, 16, v137
    v_and_b32 v125, 0xffff0000, v137
    v_mul_f32 v112, v8, v112
    v_mul_f32 v124, v8, v124
    v_mul_f32 v113, v8, v113
    v_mul_f32 v125, v8, v125
    v_mul_f32 v112, s7, v112
    v_mul_f32 v124, s7, v124
    v_mul_f32 v118, s8, v113
    v_mul_f32 v130, s8, v125
    v_fma_f32 v119, v113, s8, -v118
    v_fma_f32 v131, v125, s8, -v130
    v_fmac_f32 v119, 0x31dc9c88, v113
    v_fmac_f32 v131, 0x31dc9c88, v125
    v_exp_f32 v120, v112
    v_exp_f32 v132, v124
    v_fract_f32 v121, v118
    v_fract_f32 v133, v130
    v_add_f32 v121, v121, v119
    v_add_f32 v133, v133, v131
    v_cos_f32 v122, v121
    v_cos_f32 v134, v133
    v_sin_f32 v123, v121
    v_sin_f32 v135, v133
    v_mul_f32 v180, v120, v122
    v_mul_f32 v183, v132, v134
    v_mul_f32 v181, v120, v123
    v_mul_f32 v184, v132, v135
    v_xor_b32 v182, 0x80000000, v181
    v_xor_b32 v185, 0x80000000, v184
    v_mul_f32 v120, 0x43800000, v112
    v_mul_f32 v132, 0x43800000, v124
    v_mul_f32 v121, 0x43800000, v118
    v_mul_f32 v133, 0x43800000, v130
    v_exp_f32 v120, v120
    v_exp_f32 v132, v132
    v_fract_f32 v121, v121
    v_fract_f32 v133, v133
    v_fmac_f32 v121, 0x43800000, v119
    v_fmac_f32 v133, 0x43800000, v131
    v_cos_f32 v122, v121
    v_cos_f32 v134, v133
    v_sin_f32 v123, v121
    v_sin_f32 v135, v133
    v_mul_f32 v192, v120, v122
    v_mul_f32 v195, v132, v134
    v_mul_f32 v193, v120, v123
    v_mul_f32 v196, v132, v135
    v_xor_b32 v194, 0x80000000, v193
    v_xor_b32 v197, 0x80000000, v196
    v_mul_f32 v120, 0x41000000, v112
    v_mul_f32 v132, 0x41000000, v124
    v_mul_f32 v121, 0x41000000, v118
    v_mul_f32 v133, 0x41000000, v130
    v_exp_f32 v120, v120
    v_exp_f32 v132, v132
    v_fract_f32 v121, v121
    v_fract_f32 v133, v133
    v_fmac_f32 v121, 0x41000000, v119
    v_fmac_f32 v133, 0x41000000, v131
    v_cos_f32 v122, v121
    v_cos_f32 v134, v133
    v_sin_f32 v123, v121
    v_sin_f32 v135, v133
    v_mul_f32 v186, v120, v122
    v_mul_f32 v189, v132, v134
    v_mul_f32 v187, v120, v123
    v_mul_f32 v190, v132, v135
    v_xor_b32 v188, 0x80000000, v187
    v_xor_b32 v191, 0x80000000, v190
    s_waitcnt vmcnt(3)
    v_lshlrev_b32 v114, 16, v138
    v_and_b32 v126, 0xffff0000, v138
    s_waitcnt vmcnt(2)
    v_lshlrev_b32 v115, 16, v139
    v_and_b32 v127, 0xffff0000, v139
    s_waitcnt vmcnt(1)
    v_lshlrev_b32 v116, 16, v140
    v_and_b32 v128, 0xffff0000, v140
    s_waitcnt vmcnt(0)
    v_lshlrev_b32 v117, 16, v141
    v_and_b32 v129, 0xffff0000, v141
    v_mul_f32 v114, v8, v114
    v_mul_f32 v126, v8, v126
    v_mul_f32 v115, v8, v115
    v_mul_f32 v127, v8, v127
    v_mul_f32 v148, v116, v114
    v_mul_f32 v156, v128, v126
    v_mul_f32 v149, v117, v114
    v_mul_f32 v157, v129, v126
    v_fma_f32 v148, -v117, v115, v148
    v_fma_f32 v156, -v129, v127, v156
    v_fmac_f32 v149, v116, v115
    v_fmac_f32 v157, v128, v127
    v_cmp_eq_u32 vcc, 0, v1
    v_mov_b32 v240, s101
    s_nop 0
    v_cndmask_b32 v240, 0, v240, vcc
    v_cvt_pk_bf16_f32 v172, v148, -v149
    v_cvt_pk_bf16_f32 v173, v156, -v157
    v_mul_f32 v164, v148, v180
    v_mul_f32 v166, v156, v183
    v_mul_f32 v165, v149, v180
    v_mul_f32 v167, v157, v183
    v_fmac_f32 v164, v149, v182
    v_fmac_f32 v166, v157, v185
    v_fmac_f32 v165, v148, v181
    v_fmac_f32 v167, v156, v184
    v_cvt_pk_bf16_f32 v174, v164, -v165
    v_cvt_pk_bf16_f32 v175, v166, -v167
    ds_write_b128 v237, v[172:175] offset:0
    v_mul_f32 v150, v164, v180
    v_mul_f32 v158, v166, v183
    v_mul_f32 v151, v165, v180
    v_mul_f32 v159, v167, v183
    v_fmac_f32 v150, v165, v182
    v_fmac_f32 v158, v167, v185
    v_fmac_f32 v151, v164, v181
    v_fmac_f32 v159, v166, v184
    v_cvt_pk_bf16_f32 v176, v150, -v151
    v_cvt_pk_bf16_f32 v177, v158, -v159
    v_mul_f32 v164, v150, v180
    v_mul_f32 v166, v158, v183
    v_mul_f32 v165, v151, v180
    v_mul_f32 v167, v159, v183
    v_fmac_f32 v164, v151, v182
    v_fmac_f32 v166, v159, v185
    v_fmac_f32 v165, v150, v181
    v_fmac_f32 v167, v158, v184
    v_cvt_pk_bf16_f32 v178, v164, -v165
    v_cvt_pk_bf16_f32 v179, v166, -v167
    ds_write_b128 v237, v[176:179] offset:1040
    v_mul_f32 v152, v164, v180
    v_mul_f32 v160, v166, v183
    v_mul_f32 v153, v165, v180
    v_mul_f32 v161, v167, v183
    v_fmac_f32 v152, v165, v182
    v_fmac_f32 v160, v167, v185
    v_fmac_f32 v153, v164, v181
    v_fmac_f32 v161, v166, v184
    v_cvt_pk_bf16_f32 v172, v152, -v153
    v_cvt_pk_bf16_f32 v173, v160, -v161
    v_mul_f32 v164, v152, v180
    v_mul_f32 v166, v160, v183
    v_mul_f32 v165, v153, v180
    v_mul_f32 v167, v161, v183
    v_fmac_f32 v164, v153, v182
    v_fmac_f32 v166, v161, v185
    v_fmac_f32 v165, v152, v181
    v_fmac_f32 v167, v160, v184
    v_cvt_pk_bf16_f32 v174, v164, -v165
    v_cvt_pk_bf16_f32 v175, v166, -v167
    ds_write_b128 v237, v[172:175] offset:2080
    v_mul_f32 v154, v164, v180
    v_mul_f32 v162, v166, v183
    v_mul_f32 v155, v165, v180
    v_mul_f32 v163, v167, v183
    v_fmac_f32 v154, v165, v182
    v_fmac_f32 v162, v167, v185
    v_fmac_f32 v155, v164, v181
    v_fmac_f32 v163, v166, v184
    v_cvt_pk_bf16_f32 v176, v154, -v155
    v_cvt_pk_bf16_f32 v177, v162, -v163
    v_mul_f32 v164, v154, v180
    v_mul_f32 v166, v162, v183
    v_mul_f32 v165, v155, v180
    v_mul_f32 v167, v163, v183
    v_fmac_f32 v164, v155, v182
    v_fmac_f32 v166, v163, v185
    v_fmac_f32 v165, v154, v181
    v_fmac_f32 v167, v162, v184
    v_cvt_pk_bf16_f32 v178, v164, -v165
    v_cvt_pk_bf16_f32 v179, v166, -v167
    ds_write_b128 v237, v[176:179] offset:3120
    v_mul_f32 v136, v148, v192
    v_mul_f32 v140, v156, v195
    v_mul_f32 v137, v149, v192
    v_mul_f32 v141, v157, v195
    v_fmac_f32 v136, v149, v194
    v_fmac_f32 v140, v157, v197
    v_fmac_f32 v137, v148, v193
    v_fmac_f32 v141, v156, v196
    v_cvt_pk_bf16_f32 v172, v136, -v137
    v_cvt_pk_bf16_f32 v173, v140, -v141
    v_mul_f32 v164, v150, v192
    v_mul_f32 v166, v158, v195
    v_mul_f32 v165, v151, v192
    v_mul_f32 v167, v159, v195
    v_fmac_f32 v164, v151, v194
    v_fmac_f32 v166, v159, v197
    v_fmac_f32 v165, v150, v193
    v_fmac_f32 v167, v158, v196
    v_cvt_pk_bf16_f32 v174, v164, -v165
    v_cvt_pk_bf16_f32 v175, v166, -v167
    ds_write_b128 v237, v[172:175] offset:4160
    v_mul_f32 v138, v152, v192
    v_mul_f32 v142, v160, v195
    v_mul_f32 v139, v153, v192
    v_mul_f32 v143, v161, v195
    v_fmac_f32 v138, v153, v194
    v_fmac_f32 v142, v161, v197
    v_fmac_f32 v139, v152, v193
    v_fmac_f32 v143, v160, v196
    v_cvt_pk_bf16_f32 v176, v138, -v139
    v_cvt_pk_bf16_f32 v177, v142, -v143
    v_mul_f32 v164, v154, v192
    v_mul_f32 v166, v162, v195
    v_mul_f32 v165, v155, v192
    v_mul_f32 v167, v163, v195
    v_fmac_f32 v164, v155, v194
    v_fmac_f32 v166, v163, v197
    v_fmac_f32 v165, v154, v193
    v_fmac_f32 v167, v162, v196
    v_cvt_pk_bf16_f32 v178, v164, -v165
    v_cvt_pk_bf16_f32 v179, v166, -v167
    ds_write_b128 v237, v[176:179] offset:5200
    v_mul_f32 v148, v136, v192
    v_mul_f32 v156, v140, v195
    v_mul_f32 v149, v137, v192
    v_mul_f32 v157, v141, v195
    v_fmac_f32 v148, v137, v194
    v_fmac_f32 v156, v141, v197
    v_fmac_f32 v149, v136, v193
    v_fmac_f32 v157, v140, v196
    v_cvt_pk_bf16_f32 v172, v148, -v149
    v_cvt_pk_bf16_f32 v173, v156, -v157
    v_mul_f32 v150, v138, v192
    v_mul_f32 v158, v142, v195
    v_mul_f32 v151, v139, v192
    v_mul_f32 v159, v143, v195
    v_fmac_f32 v150, v139, v194
    v_fmac_f32 v158, v143, v197
    v_fmac_f32 v151, v138, v193
    v_fmac_f32 v159, v142, v196
    v_cvt_pk_bf16_f32 v174, v150, -v151
    v_cvt_pk_bf16_f32 v175, v158, -v159
    ds_write_b128 v237, v[172:175] offset:6240
    v_mul_f32 v136, v148, v192
    v_mul_f32 v140, v156, v195
    v_mul_f32 v137, v149, v192
    v_mul_f32 v141, v157, v195
    v_fmac_f32 v136, v149, v194
    v_fmac_f32 v140, v157, v197
    v_fmac_f32 v137, v148, v193
    v_fmac_f32 v141, v156, v196
    v_cvt_pk_bf16_f32 v176, v136, -v137
    v_cvt_pk_bf16_f32 v177, v140, -v141
    v_mul_f32 v138, v150, v192
    v_mul_f32 v142, v158, v195
    v_mul_f32 v139, v151, v192
    v_mul_f32 v143, v159, v195
    v_fmac_f32 v138, v151, v194
    v_fmac_f32 v142, v159, v197
    v_fmac_f32 v139, v150, v193
    v_fmac_f32 v143, v158, v196
    v_cvt_pk_bf16_f32 v178, v138, -v139
    v_cvt_pk_bf16_f32 v179, v142, -v143
    ds_write_b128 v237, v[176:179] offset:7280
    v_mul_f32 v164, v136, v192
    v_mul_f32 v166, v140, v195
    v_mul_f32 v165, v137, v192
    v_mul_f32 v167, v141, v195
    v_fmac_f32 v164, v137, v194
    v_fmac_f32 v166, v141, v197
    v_fmac_f32 v165, v136, v193
    v_fmac_f32 v167, v140, v196
    v_cvt_pk_bf16_f32 v172, v164, -v165
    v_cvt_pk_bf16_f32 v173, v166, -v167
    v_mul_f32 v168, v164, v192
    v_mul_f32 v170, v166, v195
    v_mul_f32 v169, v165, v192
    v_mul_f32 v171, v167, v195
    v_fmac_f32 v168, v165, v194
    v_fmac_f32 v170, v167, v197
    v_fmac_f32 v169, v164, v193
    v_fmac_f32 v171, v166, v196
    v_cvt_pk_bf16_f32 v174, v168, -v169
    v_cvt_pk_bf16_f32 v175, v170, -v171
    ds_write_b128 v237, v[172:175] offset:8320
    v_mul_f32 v164, v168, v192
    v_mul_f32 v166, v170, v195
    v_mul_f32 v165, v169, v192
    v_mul_f32 v167, v171, v195
    v_fmac_f32 v164, v169, v194
    v_fmac_f32 v166, v171, v197
    v_fmac_f32 v165, v168, v193
    v_fmac_f32 v167, v170, v196
    v_cvt_pk_bf16_f32 v176, v164, -v165
    v_cvt_pk_bf16_f32 v177, v166, -v167
    v_mul_f32 v168, v164, v192
    v_mul_f32 v170, v166, v195
    v_mul_f32 v169, v165, v192
    v_mul_f32 v171, v167, v195
    v_fmac_f32 v168, v165, v194
    v_fmac_f32 v170, v167, v197
    v_fmac_f32 v169, v164, v193
    v_fmac_f32 v171, v166, v196
    v_cvt_pk_bf16_f32 v178, v168, -v169
    v_cvt_pk_bf16_f32 v179, v170, -v171
    ds_write_b128 v237, v[176:179] offset:9360
    v_mul_f32 v164, v168, v192
    v_mul_f32 v166, v170, v195
    v_mul_f32 v165, v169, v192
    v_mul_f32 v167, v171, v195
    v_fmac_f32 v164, v169, v194
    v_fmac_f32 v166, v171, v197
    v_fmac_f32 v165, v168, v193
    v_fmac_f32 v167, v170, v196
    v_cvt_pk_bf16_f32 v172, v164, -v165
    v_cvt_pk_bf16_f32 v173, v166, -v167
    ds_write_b128 v237, v[172:175] offset:10400
    ds_read2_b64 v[28:31], v238 offset0:0 offset1:2
    ds_read2_b64 v[32:35], v238 offset0:16 offset1:18
    ds_read2_b64 v[36:39], v238 offset0:32 offset1:34
    ds_read2_b64 v[40:43], v238 offset0:48 offset1:50
    ds_read2_b64 v[44:47], v238 offset0:64 offset1:66
    ds_read2_b64 v[48:51], v238 offset0:80 offset1:82
    ds_read2_b64 v[52:55], v238 offset0:96 offset1:98
    ds_read2_b64 v[56:59], v238 offset0:112 offset1:114
    ds_read2_b64 v[60:63], v239 offset0:0 offset1:2
    ds_read2_b64 v[64:67], v239 offset0:16 offset1:18
    ds_read2_b64 v[68:71], v239 offset0:32 offset1:34
    ds_read2_b64 v[72:75], v239 offset0:48 offset1:50
    ds_read2_b64 v[76:79], v239 offset0:64 offset1:66
    ds_read2_b64 v[80:83], v239 offset0:80 offset1:82
    ds_read2_b64 v[84:87], v239 offset0:96 offset1:98
    ds_read2_b64 v[88:91], v239 offset0:112 offset1:114
    s_setprio 3
    s_add_u32 m0, s64, 0
    s_add_u32 s5, s74, 0
    s_nop 0
    buffer_load_dwordx4 v220, s[60:63], s5 offen lds
    s_add_u32 m0, s64, 1024
    s_add_u32 s5, s74, 5120
    buffer_load_dwordx4 v220, s[60:63], s5 offen lds
    s_add_u32 m0, s64, 2048
    s_add_u32 s5, s74, 10240
    buffer_load_dwordx4 v220, s[60:63], s5 offen lds
    s_add_u32 m0, s64, 3072
    s_add_u32 s5, s74, 15360
    buffer_load_dwordx4 v220, s[60:63], s5 offen lds
    s_setprio 0
    v_mov_b32 v164, 1.0
    v_mov_b32 v165, 0
    v_mov_b32 v166, 1.0
    v_mov_b32_e64 v167, 0
    v_cvt_pk_bf16_f32 v172, v164, v165
    v_cvt_pk_bf16_f32 v173, v166, v167
    v_mul_f32 v168, v164, v186
    v_mul_f32 v170, v166, v189
    v_mul_f32 v169, v165, v186
    v_mul_f32 v171, v167, v189
    v_fmac_f32 v168, v165, v188
    v_fmac_f32 v170, v167, v191
    v_fmac_f32 v169, v164, v187
    v_fmac_f32 v171, v166, v190
    v_cvt_pk_bf16_f32 v174, v168, v169
    v_cvt_pk_bf16_f32 v175, v170, v171
    ds_write_b128 v237, v[172:175] offset:0
    v_mul_f32 v164, v168, v186
    v_mul_f32 v166, v170, v189
    v_mul_f32 v165, v169, v186
    v_mul_f32 v167, v171, v189
    v_fmac_f32 v164, v169, v188
    v_fmac_f32 v166, v171, v191
    v_fmac_f32 v165, v168, v187
    v_fmac_f32 v167, v170, v190
    v_cvt_pk_bf16_f32 v176, v164, v165
    v_cvt_pk_bf16_f32 v177, v166, v167
    v_mul_f32 v168, v164, v186
    v_mul_f32 v170, v166, v189
    v_mul_f32 v169, v165, v186
    v_mul_f32 v171, v167, v189
    v_fmac_f32 v168, v165, v188
    v_fmac_f32 v170, v167, v191
    v_fmac_f32 v169, v164, v187
    v_fmac_f32 v171, v166, v190
    v_cvt_pk_bf16_f32 v178, v168, v169
    v_cvt_pk_bf16_f32 v179, v170, v171
    ds_write_b128 v237, v[176:179] offset:1040
    v_mul_f32 v164, v168, v186
    v_mul_f32 v166, v170, v189
    v_mul_f32 v165, v169, v186
    v_mul_f32 v167, v171, v189
    v_fmac_f32 v164, v169, v188
    v_fmac_f32 v166, v171, v191
    v_fmac_f32 v165, v168, v187
    v_fmac_f32 v167, v170, v190
    v_cvt_pk_bf16_f32 v172, v164, v165
    v_cvt_pk_bf16_f32 v173, v166, v167
    v_mul_f32 v168, v164, v186
    v_mul_f32 v170, v166, v189
    v_mul_f32 v169, v165, v186
    v_mul_f32 v171, v167, v189
    v_fmac_f32 v168, v165, v188
    v_fmac_f32 v170, v167, v191
    v_fmac_f32 v169, v164, v187
    v_fmac_f32 v171, v166, v190
    v_cvt_pk_bf16_f32 v174, v168, v169
    v_cvt_pk_bf16_f32 v175, v170, v171
    ds_write_b128 v237, v[172:175] offset:2080
    v_mul_f32 v164, v168, v186
    v_mul_f32 v166, v170, v189
    v_mul_f32 v165, v169, v186
    v_mul_f32 v167, v171, v189
    v_fmac_f32 v164, v169, v188
    v_fmac_f32 v166, v171, v191
    v_fmac_f32 v165, v168, v187
    v_fmac_f32 v167, v170, v190
    v_cvt_pk_bf16_f32 v176, v164, v165
    v_cvt_pk_bf16_f32 v177, v166, v167
    v_mul_f32 v168, v164, v186
    v_mul_f32 v170, v166, v189
    v_mul_f32 v169, v165, v186
    v_mul_f32 v171, v167, v189
    v_fmac_f32 v168, v165, v188
    v_fmac_f32 v170, v167, v191
    v_fmac_f32 v169, v164, v187
    v_fmac_f32 v171, v166, v190
    v_cvt_pk_bf16_f32 v178, v168, v169
    v_cvt_pk_bf16_f32 v179, v170, v171
    ds_write_b128 v237, v[176:179] offset:3120
    v_mul_f32 v164, v168, v186
    v_mul_f32 v166, v170, v189
    v_mul_f32 v165, v169, v186
    v_mul_f32 v167, v171, v189
    v_fmac_f32 v164, v169, v188
    v_fmac_f32 v166, v171, v191
    v_fmac_f32 v165, v168, v187
    v_fmac_f32 v167, v170, v190
    v_cvt_pk_bf16_f32 v172, v164, v165
    v_cvt_pk_bf16_f32 v173, v166, v167
    v_mul_f32 v168, v164, v186
    v_mul_f32 v170, v166, v189
    v_mul_f32 v169, v165, v186
    v_mul_f32 v171, v167, v189
    v_fmac_f32 v168, v165, v188
    v_fmac_f32 v170, v167, v191
    v_fmac_f32 v169, v164, v187
    v_fmac_f32 v171, v166, v190
    v_cvt_pk_bf16_f32 v174, v168, v169
    v_cvt_pk_bf16_f32 v175, v170, v171
    ds_write_b128 v237, v[172:175] offset:4160
    v_mul_f32 v164, v168, v186
    v_mul_f32 v166, v170, v189
    v_mul_f32 v165, v169, v186
    v_mul_f32 v167, v171, v189
    v_fmac_f32 v164, v169, v188
    v_fmac_f32 v166, v171, v191
    v_fmac_f32 v165, v168, v187
    v_fmac_f32 v167, v170, v190
    v_cvt_pk_bf16_f32 v176, v164, v165
    v_cvt_pk_bf16_f32 v177, v166, v167
    v_mul_f32 v168, v164, v186
    v_mul_f32 v170, v166, v189
    v_mul_f32 v169, v165, v186
    v_mul_f32 v171, v167, v189
    v_fmac_f32 v168, v165, v188
    v_fmac_f32 v170, v167, v191
    v_fmac_f32 v169, v164, v187
    v_fmac_f32 v171, v166, v190
    v_cvt_pk_bf16_f32 v178, v168, v169
    v_cvt_pk_bf16_f32 v179, v170, v171
    ds_write_b128 v237, v[176:179] offset:5200
    v_mul_f32 v164, v168, v186
    v_mul_f32 v166, v170, v189
    v_mul_f32 v165, v169, v186
    v_mul_f32 v167, v171, v189
    v_fmac_f32 v164, v169, v188
    v_fmac_f32 v166, v171, v191
    v_fmac_f32 v165, v168, v187
    v_fmac_f32 v167, v170, v190
    v_cvt_pk_bf16_f32 v172, v164, v165
    v_cvt_pk_bf16_f32 v173, v166, v167
    v_mul_f32 v168, v164, v186
    v_mul_f32 v170, v166, v189
    v_mul_f32 v169, v165, v186
    v_mul_f32 v171, v167, v189
    v_fmac_f32 v168, v165, v188
    v_fmac_f32 v170, v167, v191
    v_fmac_f32 v169, v164, v187
    v_fmac_f32 v171, v166, v190
    v_cvt_pk_bf16_f32 v174, v168, v169
    v_cvt_pk_bf16_f32 v175, v170, v171
    ds_write_b128 v237, v[172:175] offset:6240
    v_mul_f32 v164, v168, v186
    v_mul_f32 v166, v170, v189
    v_mul_f32 v165, v169, v186
    v_mul_f32 v167, v171, v189
    v_fmac_f32 v164, v169, v188
    v_fmac_f32 v166, v171, v191
    v_fmac_f32 v165, v168, v187
    v_fmac_f32 v167, v170, v190
    v_cvt_pk_bf16_f32 v176, v164, v165
    v_cvt_pk_bf16_f32 v177, v166, v167
    v_mul_f32 v168, v164, v186
    v_mul_f32 v170, v166, v189
    v_mul_f32 v169, v165, v186
    v_mul_f32 v171, v167, v189
    v_fmac_f32 v168, v165, v188
    v_fmac_f32 v170, v167, v191
    v_fmac_f32 v169, v164, v187
    v_fmac_f32 v171, v166, v190
    v_cvt_pk_bf16_f32 v178, v168, v169
    v_cvt_pk_bf16_f32 v179, v170, v171
    ds_write_b128 v237, v[176:179] offset:7280
    ds_read2_b64 v[92:95], v238 offset0:0 offset1:2
    ds_read2_b64 v[96:99], v238 offset0:16 offset1:18
    ds_read2_b64 v[100:103], v238 offset0:32 offset1:34
    ds_read2_b64 v[104:107], v238 offset0:48 offset1:50
    ds_read2_b64 v[108:111], v238 offset0:64 offset1:66
    ds_read2_b64 v[112:115], v238 offset0:80 offset1:82
    ds_read2_b64 v[116:119], v238 offset0:96 offset1:98
    ds_read2_b64 v[120:123], v238 offset0:112 offset1:114
    v_mul_f32 v164, v168, v186
    v_mul_f32 v166, v170, v189
    v_mul_f32 v165, v169, v186
    v_mul_f32 v167, v171, v189
    v_fmac_f32 v164, v169, v188
    v_fmac_f32 v166, v171, v191
    v_fmac_f32 v165, v168, v187
    v_fmac_f32 v167, v170, v190
    v_cvt_pk_bf16_f32 v172, v164, v165
    v_cvt_pk_bf16_f32 v173, v166, v167
    v_mul_f32 v168, v164, v186
    s_waitcnt lgkmcnt(7)
    v_mfma_f32_16x16x32_bf16 v[124:127], v[28:31], v[92:95], 0
    v_mul_f32 v170, v166, v189
    v_mul_f32 v169, v165, v186
    v_mul_f32 v171, v167, v189
    v_fmac_f32 v168, v165, v188
    v_fmac_f32 v170, v167, v191
    v_fmac_f32 v169, v164, v187
    v_fmac_f32_e64 v171, v166, v190
    v_cvt_pk_bf16_f32 v174, v168, v169
    v_cvt_pk_bf16_f32 v175, v170, v171
    ds_write_b128 v237, v[172:175] offset:0
    v_mfma_f32_16x16x32_bf16 v[128:131], v[92:95], v[60:63], 0
    v_mul_f32 v164, v168, v186
    v_mul_f32 v166, v170, v189
    v_mul_f32 v165, v169, v186
    v_mul_f32 v167, v171, v189
    v_fmac_f32 v164, v169, v188
    v_fmac_f32 v166, v171, v191
    v_fmac_f32 v165, v168, v187
    v_fmac_f32 v167, v170, v190
    v_cvt_pk_bf16_f32 v176, v164, v165
    v_cvt_pk_bf16_f32 v177, v166, v167
    v_mul_f32 v168, v164, v186
    s_waitcnt lgkmcnt(7)
    v_mfma_f32_16x16x32_bf16 v[124:127], v[32:35], v[96:99], v[124:127]
    v_mul_f32 v170, v166, v189
    v_mul_f32 v169, v165, v186
    v_mul_f32 v171, v167, v189
    v_fmac_f32 v168, v165, v188
    v_fmac_f32 v170, v167, v191
    v_fmac_f32 v169, v164, v187
    v_fmac_f32_e64 v171, v166, v190
    v_cvt_pk_bf16_f32 v178, v168, v169
    v_cvt_pk_bf16_f32 v179, v170, v171
    ds_write_b128 v237, v[176:179] offset:1040
    v_mfma_f32_16x16x32_bf16 v[128:131], v[96:99], v[64:67], v[128:131]
    v_mul_f32 v164, v168, v186
    v_mul_f32 v166, v170, v189
    v_mul_f32 v165, v169, v186
    v_mul_f32 v167, v171, v189
    v_fmac_f32 v164, v169, v188
    v_fmac_f32 v166, v171, v191
    v_fmac_f32 v165, v168, v187
    v_fmac_f32 v167, v170, v190
    v_cvt_pk_bf16_f32 v172, v164, v165
    v_cvt_pk_bf16_f32 v173, v166, v167
    v_mul_f32 v168, v164, v186
    s_waitcnt lgkmcnt(7)
    v_mfma_f32_16x16x32_bf16 v[124:127], v[36:39], v[100:103], v[124:127]
    v_mul_f32 v170, v166, v189
    v_mul_f32 v169, v165, v186
    v_mul_f32 v171, v167, v189
    v_fmac_f32 v168, v165, v188
    v_fmac_f32 v170, v167, v191
    v_fmac_f32 v169, v164, v187
    v_fmac_f32_e64 v171, v166, v190
    v_cvt_pk_bf16_f32 v174, v168, v169
    v_cvt_pk_bf16_f32 v175, v170, v171
    ds_write_b128 v237, v[172:175] offset:2080
    v_mfma_f32_16x16x32_bf16 v[128:131], v[100:103], v[68:71], v[128:131]
    v_mul_f32 v164, v168, v186
    v_mul_f32 v166, v170, v189
    v_mul_f32 v165, v169, v186
    v_mul_f32 v167, v171, v189
    v_fmac_f32 v164, v169, v188
    v_fmac_f32 v166, v171, v191
    v_fmac_f32 v165, v168, v187
    v_fmac_f32 v167, v170, v190
    v_cvt_pk_bf16_f32 v176, v164, v165
    v_cvt_pk_bf16_f32 v177, v166, v167
    v_mul_f32 v168, v164, v186
    s_waitcnt lgkmcnt(7)
    v_mfma_f32_16x16x32_bf16 v[124:127], v[40:43], v[104:107], v[124:127]
    v_mul_f32 v170, v166, v189
    v_mul_f32 v169, v165, v186
    v_mul_f32 v171, v167, v189
    v_fmac_f32 v168, v165, v188
    v_fmac_f32 v170, v167, v191
    v_fmac_f32 v169, v164, v187
    v_fmac_f32_e64 v171, v166, v190
    v_cvt_pk_bf16_f32 v178, v168, v169
    v_cvt_pk_bf16_f32 v179, v170, v171
    ds_write_b128 v237, v[176:179] offset:3120
    v_mfma_f32_16x16x32_bf16 v[128:131], v[104:107], v[72:75], v[128:131]
    v_mul_f32 v164, v168, v186
    v_mul_f32 v166, v170, v189
    v_mul_f32 v165, v169, v186
    v_mul_f32 v167, v171, v189
    v_fmac_f32 v164, v169, v188
    v_fmac_f32 v166, v171, v191
    v_fmac_f32 v165, v168, v187
    v_fmac_f32 v167, v170, v190
    v_cvt_pk_bf16_f32 v172, v164, v165
    v_cvt_pk_bf16_f32 v173, v166, v167
    v_mul_f32 v168, v164, v186
    s_waitcnt lgkmcnt(7)
    v_mfma_f32_16x16x32_bf16 v[124:127], v[44:47], v[108:111], v[124:127]
    v_mul_f32 v170, v166, v189
    v_mul_f32 v169, v165, v186
    v_mul_f32 v171, v167, v189
    v_fmac_f32 v168, v165, v188
    v_fmac_f32 v170, v167, v191
    v_fmac_f32 v169, v164, v187
    v_fmac_f32_e64 v171, v166, v190
    v_cvt_pk_bf16_f32 v174, v168, v169
    v_cvt_pk_bf16_f32 v175, v170, v171
    ds_write_b128 v237, v[172:175] offset:4160
    v_mfma_f32_16x16x32_bf16 v[128:131], v[108:111], v[76:79], v[128:131]
    v_mul_f32 v164, v168, v186
    v_mul_f32 v166, v170, v189
    v_mul_f32 v165, v169, v186
    v_mul_f32 v167, v171, v189
    v_fmac_f32 v164, v169, v188
    v_fmac_f32 v166, v171, v191
    v_fmac_f32 v165, v168, v187
    v_fmac_f32 v167, v170, v190
    v_cvt_pk_bf16_f32 v176, v164, v165
    v_cvt_pk_bf16_f32 v177, v166, v167
    v_mul_f32 v168, v164, v186
    s_waitcnt lgkmcnt(7)
    v_mfma_f32_16x16x32_bf16 v[124:127], v[48:51], v[112:115], v[124:127]
    v_mul_f32 v170, v166, v189
    v_mul_f32 v169, v165, v186
    v_mul_f32 v171, v167, v189
    v_fmac_f32 v168, v165, v188
    v_fmac_f32 v170, v167, v191
    v_fmac_f32 v169, v164, v187
    v_fmac_f32_e64 v171, v166, v190
    v_cvt_pk_bf16_f32 v178, v168, v169
    v_cvt_pk_bf16_f32 v179, v170, v171
    ds_write_b128 v237, v[176:179] offset:5200
    v_mfma_f32_16x16x32_bf16 v[128:131], v[112:115], v[80:83], v[128:131]
    v_mul_f32 v164, v168, v186
    v_mul_f32 v166, v170, v189
    v_mul_f32 v165, v169, v186
    v_mul_f32 v167, v171, v189
    v_fmac_f32 v164, v169, v188
    v_fmac_f32 v166, v171, v191
    v_fmac_f32 v165, v168, v187
    v_fmac_f32 v167, v170, v190
    v_cvt_pk_bf16_f32 v172, v164, v165
    v_cvt_pk_bf16_f32 v173, v166, v167
    v_mul_f32 v168, v164, v186
    s_waitcnt lgkmcnt(7)
    v_mfma_f32_16x16x32_bf16 v[124:127], v[52:55], v[116:119], v[124:127]
    v_mul_f32 v170, v166, v189
    v_mul_f32 v169, v165, v186
    v_mul_f32 v171, v167, v189
    v_fmac_f32 v168, v165, v188
    v_fmac_f32 v170, v167, v191
    v_fmac_f32 v169, v164, v187
    v_fmac_f32_e64 v171, v166, v190
    v_cvt_pk_bf16_f32 v174, v168, v169
    v_cvt_pk_bf16_f32 v175, v170, v171
    ds_write_b128 v237, v[172:175] offset:6240
    v_mfma_f32_16x16x32_bf16 v[128:131], v[116:119], v[84:87], v[128:131]
    v_mul_f32 v164, v168, v186
    v_mul_f32 v166, v170, v189
    v_mul_f32 v165, v169, v186
    v_mul_f32 v167, v171, v189
    v_fmac_f32 v164, v169, v188
    v_fmac_f32 v166, v171, v191
    v_fmac_f32 v165, v168, v187
    v_fmac_f32 v167, v170, v190
    v_cvt_pk_bf16_f32 v176, v164, v165
    v_cvt_pk_bf16_f32 v177, v166, v167
    v_mul_f32 v168, v164, v186
    s_waitcnt lgkmcnt(7)
    v_mfma_f32_16x16x32_bf16 v[124:127], v[56:59], v[120:123], v[124:127]
    v_mul_f32 v170, v166, v189
    v_mul_f32 v169, v165, v186
    v_mul_f32 v171, v167, v189
    v_fmac_f32 v168, v165, v188
    v_fmac_f32 v170, v167, v191
    v_fmac_f32 v169, v164, v187
    v_fmac_f32_e64 v171, v166, v190
    v_cvt_pk_bf16_f32 v178, v168, v169
    v_cvt_pk_bf16_f32 v179, v170, v171
    ds_write_b128 v237, v[176:179] offset:7280
    v_mfma_f32_16x16x32_bf16 v[128:131], v[120:123], v[88:91], v[128:131]
    ds_read2_b64 v[92:95], v238 offset0:0 offset1:2
    ds_read2_b64 v[96:99], v238 offset0:16 offset1:18
    ds_read2_b64 v[100:103], v238 offset0:32 offset1:34
    ds_read2_b64 v[104:107], v238 offset0:48 offset1:50
    ds_read2_b64 v[108:111], v238 offset0:64 offset1:66
    ds_read2_b64 v[112:115], v238 offset0:80 offset1:82
    ds_read2_b64 v[116:119], v238 offset0:96 offset1:98
    ds_read2_b64 v[120:123], v238 offset0:112 offset1:114
    v_add_f32_e64 v124, v124, v240
    v_cvt_pk_bf16_f32 v140, v124, v125
    v_cvt_pk_bf16_f32 v141, v126, v127
    v_cvt_pk_bf16_f32 v142, v128, v130
    v_cvt_pk_bf16_f32 v143, v129, v131
    ds_write_b64 v232, v[140:141]
    ds_write2_b32 v234, v142, v143 offset0:0 offset1:68
    s_waitcnt lgkmcnt(9)
    v_mfma_f32_16x16x32_bf16 v[132:135], v[28:31], v[92:95], 0
    v_mfma_f32_16x16x32_bf16 v[136:139], v[92:95], v[60:63], 0
    s_waitcnt lgkmcnt(8)
    v_mfma_f32_16x16x32_bf16 v[132:135], v[32:35], v[96:99], v[132:135]
    v_mfma_f32_16x16x32_bf16 v[136:139], v[96:99], v[64:67], v[136:139]
    s_waitcnt lgkmcnt(7)
    v_mfma_f32_16x16x32_bf16 v[132:135], v[36:39], v[100:103], v[132:135]
    v_mfma_f32_16x16x32_bf16 v[136:139], v[100:103], v[68:71], v[136:139]
    s_waitcnt lgkmcnt(6)
    v_mfma_f32_16x16x32_bf16 v[132:135], v[40:43], v[104:107], v[132:135]
    v_mfma_f32_16x16x32_bf16 v[136:139], v[104:107], v[72:75], v[136:139]
    s_waitcnt lgkmcnt(5)
    v_mfma_f32_16x16x32_bf16 v[132:135], v[44:47], v[108:111], v[132:135]
    v_mfma_f32_16x16x32_bf16 v[136:139], v[108:111], v[76:79], v[136:139]
    s_waitcnt lgkmcnt(4)
    v_mfma_f32_16x16x32_bf16 v[132:135], v[48:51], v[112:115], v[132:135]
    v_mfma_f32_16x16x32_bf16 v[136:139], v[112:115], v[80:83], v[136:139]
    s_waitcnt lgkmcnt(3)
    v_mfma_f32_16x16x32_bf16 v[132:135], v[52:55], v[116:119], v[132:135]
    v_mfma_f32_16x16x32_bf16 v[136:139], v[116:119], v[84:87], v[136:139]
    s_waitcnt lgkmcnt(2)
    v_mfma_f32_16x16x32_bf16 v[132:135], v[56:59], v[120:123], v[132:135]
    v_mfma_f32_16x16x32_bf16 v[136:139], v[120:123], v[88:91], v[136:139]
    v_mul_u32_u24 v4, 2312, v2
    v_cmp_eq_u32_e64 vcc, 3, v2
    v_add_u32 v5, 1088, v4
    s_nop 0
    v_cndmask_b32 v4, v4, v5, vcc
    v_lshl_add_u32 v5, v3, 2, s81
    v_add_u32_e64 v4, v4, v5
    ds_write_b32 v4, v144 offset:64
    v_cvt_pk_bf16_f32 v148, v132, v133
    v_cvt_pk_bf16_f32 v149, v134, v135
    v_cvt_pk_bf16_f32 v150, v136, v138
    v_cvt_pk_bf16_f32 v151, v137, v139
    ds_write_b64 v233, v[148:149]
    ds_write2_b32 v234, v150, v151 offset0:4 offset1:72
    ds_read_u16 v9, v229
    ds_read_u16 v8, v230
    s_waitcnt lgkmcnt(0)
    v_lshl_or_b32 v9, v8, 16, v9
    ds_write_b32 v231, v9 offset:544
    s_waitcnt vmcnt(0)
    ds_read_b64_tr_b16 v[156:157], v235 offset:0
    ds_read_b64_tr_b16 v[158:159], v235 offset:1024
    ds_read_b64_tr_b16 v[160:161], v235 offset:64
    ds_read_b64_tr_b16 v[162:163], v235 offset:1088
    ds_read_b64_tr_b16 v[164:165], v235 offset:128
    ds_read_b64_tr_b16 v[166:167], v235 offset:1152
    ds_read_b64_tr_b16 v[168:169], v235 offset:192
    ds_read_b64_tr_b16 v[170:171], v235 offset:1216
    s_setprio 3
    s_buffer_load_dword s83, s[56:59], 4
    s_waitcnt lgkmcnt(0)
    s_cmp_lg_u32 s83, 0
    s_cbranch_scc1 L_nok_23
    s_mov_b32 s13, 0
L_nsp_24:
    buffer_load_dword v255, off, s[56:59], 0 offset:4 sc1
    s_add_u32 s13, s13, 1
    s_waitcnt vmcnt(0)
    v_readfirstlane_b32 s83, v255
    s_cmp_gt_u32 s13, 30000
    s_cbranch_scc1 L_nok_23
    s_cmp_eq_u32 s83, 0
    s_cbranch_scc1 L_nsp_24
    s_nop 1
L_nok_23:
    v_mov_b32 v255, s83
    s_add_u32 s5, s65, 0
    buffer_store_dwordx4 v[156:159], v236, s[48:51], s5 offen sc1
    s_add_u32 s5, s65, 131072
    buffer_store_dwordx4 v[160:163], v236, s[48:51], s5 offen sc1
    s_add_u32 s5, s65, 262144
    buffer_store_dwordx4 v[164:167], v236, s[48:51], s5 offen sc1
    s_add_u32 s5, s65, 393216
    buffer_store_dwordx4 v[168:171], v236, s[48:51], s5 offen sc1
    s_setprio 0
    s_nop 0
    ds_read2_b32 v[172:173], v222 offset0:16 offset1:17
    ds_read2_b32 v[174:175], v222 offset0:18 offset1:19
    ds_read_b32 v176, v222 offset:80
    ds_read2_b32 v[178:179], v224 offset0:0 offset1:1
    ds_read_b32 v180, v224 offset:8
    ds_read2_b32 v[182:183], v222 offset0:32 offset1:33
    ds_read2_b32 v[184:185], v222 offset0:34 offset1:35
    ds_read_b32 v186, v222 offset:144
    ds_read2_b32 v[188:189], v224 offset0:8 offset1:9
    ds_read_b32 v190, v224 offset:40
    ds_read2_b32 v[192:193], v222 offset0:48 offset1:49
    ds_read2_b32 v[194:195], v222 offset0:50 offset1:51
    ds_read_b32 v196, v222 offset:208
    ds_read2_b32 v[198:199], v224 offset0:16 offset1:17
    ds_read_b32 v200, v224 offset:72
    ds_read2_b32 v[124:125], v222 offset0:64 offset1:65
    ds_read2_b32 v[126:127], v222 offset0:66 offset1:67
    ds_read_b32 v128, v222 offset:272
    ds_read2_b32 v[130:131], v224 offset0:24 offset1:25
    ds_read_b32 v132, v224 offset:104
    ds_read2_b32 v[134:135], v222 offset0:80 offset1:81
    ds_read2_b32 v[136:137], v222 offset0:82 offset1:83
    ds_read_b32 v138, v222 offset:336
    ds_read2_b32 v[140:141], v224 offset0:32 offset1:33
    ds_read_b32 v142, v224 offset:136
    ds_read2_b32 v[144:145], v222 offset0:96 offset1:97
    ds_read2_b32 v[146:147], v222 offset0:98 offset1:99
    ds_read_b32 v148, v222 offset:400
    ds_read2_b32 v[150:151], v224 offset0:40 offset1:41
    ds_read_b32 v152, v224 offset:168
    s_waitcnt lgkmcnt(15)
    s_nop 0
    v_perm_b32 v31, v173, v172, v221
    v_perm_b32 v30, v174, v173, v221
    v_perm_b32 v29, v175, v174, v221
    v_perm_b32 v28, v176, v175, v221
    v_perm_b32 v35, v179, v178, v223
    v_perm_b32 v34, v179, v178, v225
    v_perm_b32 v33, v180, v179, v223
    v_perm_b32 v32, v180, v179, v225
    v_perm_b32 v39, v183, v182, v221
    v_perm_b32 v38, v184, v183, v221
    v_perm_b32 v37, v185, v184, v221
    v_perm_b32 v36, v186, v185, v221
    v_perm_b32 v43, v189, v188, v223
    v_perm_b32 v42, v189, v188, v225
    v_perm_b32 v41, v190, v189, v223
    v_perm_b32 v40, v190, v189, v225
    v_perm_b32 v47, v193, v192, v221
    v_perm_b32 v46, v194, v193, v221
    v_perm_b32 v45, v195, v194, v221
    v_perm_b32 v44, v196, v195, v221
    v_perm_b32 v51, v199, v198, v223
    v_perm_b32 v50, v199, v198, v225
    v_perm_b32 v49, v200, v199, v223
    v_perm_b32 v48, v200, v199, v225
    ds_read2_b32 v[172:173], v222 offset0:112 offset1:113
    ds_read2_b32 v[174:175], v222 offset0:114 offset1:115
    ds_read_b32 v176, v222 offset:464
    ds_read2_b32 v[178:179], v224 offset0:48 offset1:49
    ds_read_b32 v180, v224 offset:200
    ds_read2_b32 v[182:183], v227 offset0:0 offset1:1
    ds_read2_b32 v[184:185], v227 offset0:2 offset1:3
    ds_read_b32 v186, v227 offset:16
    ds_read2_b32 v[188:189], v227 offset0:8 offset1:9
    ds_read2_b32 v[190:191], v227 offset0:10 offset1:11
    ds_read_b32 v192, v227 offset:48
    ds_read2_b32 v[194:195], v227 offset0:16 offset1:17
    ds_read2_b32 v[196:197], v227 offset0:18 offset1:19
    ds_read_b32 v198, v227 offset:80
    s_waitcnt lgkmcnt(15)
    s_nop 0
    v_perm_b32 v55, v125, v124, v221
    v_perm_b32 v54, v126, v125, v221
    v_perm_b32 v53, v127, v126, v221
    v_perm_b32 v52, v128, v127, v221
    v_perm_b32 v59, v131, v130, v223
    v_perm_b32 v58, v131, v130, v225
    v_perm_b32 v57, v132, v131, v223
    v_perm_b32 v56, v132, v131, v225
    v_perm_b32 v63, v135, v134, v221
    v_perm_b32 v62, v136, v135, v221
    v_perm_b32 v61, v137, v136, v221
    v_perm_b32 v60, v138, v137, v221
    v_perm_b32 v67, v141, v140, v223
    v_perm_b32 v66, v141, v140, v225
    v_perm_b32 v65, v142, v141, v223
    v_perm_b32 v64, v142, v141, v225
    v_perm_b32 v71, v145, v144, v221
    v_perm_b32 v70, v146, v145, v221
    v_perm_b32 v69, v147, v146, v221
    v_perm_b32 v68, v148, v147, v221
    v_perm_b32 v75, v151, v150, v223
    v_perm_b32 v74, v151, v150, v225
    s_waitcnt lgkmcnt(14)
    s_nop 0
    v_perm_b32 v73, v152, v151, v223
    v_perm_b32 v72, v152, v151, v225
    ds_read2_b32 v[124:125], v222 offset0:0 offset1:1
    ds_read2_b32 v[126:127], v222 offset0:2 offset1:3
    ds_read_b32 v128, v222 offset:16
    ds_read2_b32 v[130:131], v222 offset0:128 offset1:129
    ds_read2_b32 v[132:133], v222 offset0:130 offset1:131
    ds_read_b32 v134, v222 offset:528
    ds_read2_b32 v[136:137], v222 offset0:152 offset1:153
    ds_read2_b32 v[138:139], v222 offset0:154 offset1:155
    ds_read_b32 v140, v222 offset:624
    ds_read2_b32 v[142:143], v222 offset0:176 offset1:177
    ds_read2_b32 v[144:145], v222 offset0:178 offset1:179
    ds_read_b32 v146, v222 offset:720
    ds_read2_b32 v[148:149], v227 offset0:24 offset1:25
    ds_read2_b32 v[150:151], v227 offset0:26 offset1:27
    ds_read_b32 v152, v227 offset:112
    s_waitcnt lgkmcnt(15)
    s_nop 0
    v_perm_b32 v79, v173, v172, v221
    v_perm_b32 v78, v174, v173, v221
    v_perm_b32 v77, v175, v174, v221
    v_perm_b32 v76, v176, v175, v221
    v_perm_b32 v83, v179, v178, v223
    v_perm_b32 v82, v179, v178, v225
    v_perm_b32 v81, v180, v179, v223
    v_perm_b32 v80, v180, v179, v225
    v_perm_b32 v87, v183, v182, v226
    v_perm_b32 v86, v184, v183, v226
    v_perm_b32 v85, v185, v184, v226
    v_perm_b32 v84, v186, v185, v226
    v_perm_b32 v91, v189, v188, v226
    v_perm_b32 v90, v190, v189, v226
    v_perm_b32 v89, v191, v190, v226
    v_perm_b32 v88, v192, v191, v226
    v_perm_b32 v95, v195, v194, v226
    v_perm_b32 v94, v196, v195, v226
    v_perm_b32 v93, v197, v196, v226
    v_perm_b32 v92, v198, v197, v226
    ds_read2_b32 v[172:173], v228 offset0:0 offset1:1
    ds_read2_b32 v[174:175], v228 offset0:2 offset1:3
    ds_read_b32 v176, v228 offset:16
    ds_read2_b32 v[178:179], v228 offset0:4 offset1:5
    ds_read2_b32 v[180:181], v228 offset0:6 offset1:7
    ds_read_b32 v182, v228 offset:32
    ds_read2_b32 v[184:185], v228 offset0:8 offset1:9
    ds_read2_b32 v[186:187], v228 offset0:10 offset1:11
    ds_read_b32 v188, v228 offset:48
    s_waitcnt lgkmcnt(15)
    s_nop 0
    v_perm_b32 v15, v125, v124, v221
    v_perm_b32 v14, v126, v125, v221
    v_perm_b32 v13, v127, v126, v221
    v_perm_b32 v12, v128, v127, v221
    v_perm_b32 v19, v131, v130, v221
    v_perm_b32 v18, v132, v131, v221
    v_perm_b32 v17, v133, v132, v221
    v_perm_b32 v16, v134, v133, v221
    v_perm_b32 v23, v137, v136, v221
    v_perm_b32 v22, v138, v137, v221
    v_perm_b32 v21, v139, v138, v221
    v_perm_b32 v20, v140, v139, v221
    s_waitcnt lgkmcnt(14)
    v_perm_b32 v27, v143, v142, v221
    s_waitcnt lgkmcnt(13)
    v_perm_b32 v26, v144, v143, v221
    v_perm_b32 v25, v145, v144, v221
    s_waitcnt lgkmcnt(12)
    v_perm_b32 v24, v146, v145, v221
    s_waitcnt lgkmcnt(11)
    v_perm_b32 v99, v149, v148, v226
    s_waitcnt lgkmcnt(10)
    v_perm_b32 v98, v150, v149, v226
    v_perm_b32 v97, v151, v150, v226
    s_waitcnt lgkmcnt(9)
    v_perm_b32 v96, v152, v151, v226
    s_setprio 3
    s_waitcnt vmcnt(0)
    s_barrier
    s_cmp_lg_u32 s76, 0
    s_cbranch_scc1 L_nofl_25
    s_mov_b32 exec_hi, 0
    buffer_store_dword v255, v250, s[48:51], s66 offen sc1
    s_mov_b64 exec, -1
L_nofl_25:
    s_setprio 0
    ds_read2_b32 v[124:125], v228 offset0:12 offset1:13
    ds_read2_b32 v[126:127], v228 offset0:14 offset1:15
    ds_read_b32 v128, v228 offset:64
    ds_read2_b32 v[130:131], v228 offset0:16 offset1:17
    ds_read2_b32 v[132:133], v228 offset0:18 offset1:19
    ds_read_b32 v134, v228 offset:80
    ds_read2_b32 v[136:137], v228 offset0:20 offset1:21
    ds_read2_b32 v[138:139], v228 offset0:22 offset1:23
    ds_read_b32 v140, v228 offset:96
    s_waitcnt lgkmcnt(15)
    v_perm_b32 v103, v173, v172, v226
    v_perm_b32 v102, v174, v173, v226
    v_perm_b32 v101, v175, v174, v226
    v_perm_b32 v100, v176, v175, v226
    s_waitcnt lgkmcnt(14)
    v_perm_b32 v107, v179, v178, v226
    s_waitcnt lgkmcnt(13)
    v_perm_b32 v106, v180, v179, v226
    v_perm_b32 v105, v181, v180, v226
    s_waitcnt lgkmcnt(12)
    v_perm_b32 v104, v182, v181, v226
    s_waitcnt lgkmcnt(11)
    v_perm_b32 v111, v185, v184, v226
    s_waitcnt lgkmcnt(10)
    v_perm_b32 v110, v186, v185, v226
    v_perm_b32 v109, v187, v186, v226
    s_waitcnt lgkmcnt(9)
    v_perm_b32 v108, v188, v187, v226
    s_waitcnt lgkmcnt(8)
    v_perm_b32 v115, v125, v124, v226
    s_waitcnt lgkmcnt(7)
    v_perm_b32 v114, v126, v125, v226
    v_perm_b32 v113, v127, v126, v226
    s_waitcnt lgkmcnt(6)
    v_perm_b32 v112, v128, v127, v226
    s_waitcnt lgkmcnt(5)
    v_perm_b32 v119, v131, v130, v226
    s_waitcnt lgkmcnt(4)
    v_perm_b32 v118, v132, v131, v226
    v_perm_b32 v117, v133, v132, v226
    s_waitcnt lgkmcnt(3)
    v_perm_b32 v116, v134, v133, v226
    s_waitcnt lgkmcnt(2)
    v_perm_b32 v123, v137, v136, v226
    s_waitcnt lgkmcnt(1)
    v_perm_b32 v122, v138, v137, v226
    v_perm_b32 v121, v139, v138, v226
    s_waitcnt lgkmcnt(0)
    v_perm_b32 v120, v140, v139, v226
    s_setprio 3
    s_waitcnt lgkmcnt(0)
    s_mov_b32 s13, 0
L_ssp_27:
    s_buffer_load_dwordx16 s[16:31], s[48:51], s67 glc
    s_add_u32 s13, s13, 1
    s_waitcnt lgkmcnt(0)
    s_cmp_gt_u32 s13, 30000
    s_cbranch_scc1 L_sok_26
    s_mov_b32 s14, s83
    s_mov_b32 s15, s83
    s_xor_b64 s[8:9], s[16:17], s[14:15]
    s_xor_b64 s[16:17], s[18:19], s[14:15]
    s_or_b64 s[8:9], s[8:9], s[16:17]
    s_xor_b64 s[16:17], s[20:21], s[14:15]
    s_or_b64 s[8:9], s[8:9], s[16:17]
    s_xor_b64 s[16:17], s[22:23], s[14:15]
    s_or_b64 s[8:9], s[8:9], s[16:17]
    s_xor_b64 s[16:17], s[24:25], s[14:15]
    s_or_b64 s[8:9], s[8:9], s[16:17]
    s_cbranch_scc0 L_sok_26
    s_sleep 2
    s_branch L_ssp_27
L_sok_26:
    s_mov_b32 m0, s64
    s_nop 0
    buffer_load_dwordx4 v246, s[48:51], s70 offen offset:0 sc1 lds
    buffer_load_dwordx4 v246, s[48:51], s70 offen offset:1024 sc1 lds
    buffer_load_dwordx4 v246, s[48:51], s70 offen offset:2048 sc1 lds
    buffer_load_dwordx4 v246, s[48:51], s70 offen offset:3072 sc1 lds
    s_setprio 0
    s_waitcnt vmcnt(0)
    s_waitcnt lgkmcnt(0)
    s_barrier
    s_setprio 0
    s_nop 0
    ds_read_b128 v[124:127], v251 offset:1024
    ds_read_b128 v[128:131], v251 offset:3072
    ds_read_b128 v[132:135], v251 offset:5120
    ds_read_b128 v[136:139], v251 offset:7168
    ds_read_b128 v[140:143], v251 offset:9216
    ds_read_b128 v[144:147], v251 offset:11264
    ds_read_b128 v[148:151], v251 offset:13312
    ds_read_b128 v[152:155], v251 offset:15360
    s_mul_i32 s4, s76, 144
    v_add_u32 v4, s4, v248
    v_lshrrev_b32 v7, 2, v3
    v_mul_u32_u24 v5, 11584, v7
    v_bfe_u32 v7, v1, 1, 1
    v_lshl_add_u32 v5, v7, 5, v5
    v_and_b32 v7, 1, v1
    v_lshrrev_b32 v6, 5, v1
    v_add_lshl_u32 v7, v7, v6, 3
    v_lshl_add_u32 v7, v2, 6, v7
    s_mul_i32 s4, s76, 1088
    s_add_u32 s4, s4, 36864
    v_add3_u32 v5, v5, v7, s4
    s_waitcnt lgkmcnt(7)
    s_nop 0
    v_mfma_f32_16x16x32_bf16 v[156:159], v[204:207], v[124:127], 0
    v_mfma_f32_16x16x32_bf16 v[160:163], v[208:211], v[124:127], 0
    v_mfma_f32_16x16x32_bf16 v[164:167], v[212:215], v[124:127], 0
    v_mfma_f32_16x16x32_bf16 v[168:171], v[216:219], v[124:127], 0
    v_mfma_f32_16x16x32_bf16 v[172:175], v[12:15], v[124:127], 0
    v_mfma_f32_16x16x32_bf16 v[176:179], v[16:19], v[124:127], 0
    s_nop 2
    s_nop 0
    v_cvt_pk_bf16_f32 v156, v156, v157
    v_cvt_pk_bf16_f32 v157, v158, v159
    v_mfma_f32_16x16x32_bf16 v[180:183], v[20:23], v[124:127], 0
    v_cvt_pk_bf16_f32 v160, v160, v161
    v_mfma_f32_16x16x32_bf16 v[188:191], v[24:27], v[124:127], 0
    ds_read_b128 v[124:127], v252 offset:1024
    v_cvt_pk_bf16_f32 v161, v162, v163
    s_waitcnt lgkmcnt(7)
    s_nop 0
    v_mfma_f32_16x16x32_bf16 v[220:223], v[204:207], v[128:131], 0
    ds_write_b64 v248, v[156:157] offset:136
    v_cvt_pk_bf16_f32 v164, v164, v165
    v_mfma_f32_16x16x32_bf16 v[224:227], v[208:211], v[128:131], 0
    ds_write_b64 v248, v[160:161] offset:2448
    v_cvt_pk_bf16_f32 v165, v166, v167
    v_mfma_f32_16x16x32_bf16 v[228:231], v[212:215], v[128:131], 0
    v_cvt_pk_bf16_f32 v168, v168, v169
    v_mfma_f32_16x16x32_bf16 v[232:235], v[216:219], v[128:131], 0
    ds_write_b64 v248, v[164:165] offset:4760
    v_cvt_pk_bf16_f32 v169, v170, v171
    v_mfma_f32_16x16x32_bf16 v[176:179], v[12:15], v[128:131], v[176:179]
    ds_write_b64 v248, v[168:169] offset:8160
    v_mfma_f32_16x16x32_bf16 v[180:183], v[16:19], v[128:131], v[180:183]
    v_cvt_pk_bf16_f32 v220, v220, v221
    v_cvt_pk_bf16_f32 v221, v222, v223
    v_mfma_f32_16x16x32_bf16 v[184:187], v[20:23], v[128:131], 0
    v_cvt_pk_bf16_f32 v224, v224, v225
    v_mfma_f32_16x16x32_bf16 v[192:195], v[24:27], v[128:131], 0
    ds_read_b128 v[128:131], v252 offset:3072
    v_cvt_pk_bf16_f32 v225, v226, v227
    s_waitcnt lgkmcnt(11)
    s_nop 0
    v_mfma_f32_16x16x32_bf16 v[156:159], v[204:207], v[132:135], 0
    ds_write_b64 v248, v[220:221] offset:680
    v_cvt_pk_bf16_f32 v228, v228, v229
    v_mfma_f32_16x16x32_bf16 v[160:163], v[208:211], v[132:135], 0
    ds_write_b64 v248, v[224:225] offset:2992
    v_cvt_pk_bf16_f32 v229, v230, v231
    v_mfma_f32_16x16x32_bf16 v[164:167], v[212:215], v[132:135], 0
    v_cvt_pk_bf16_f32 v232, v232, v233
    v_mfma_f32_16x16x32_bf16 v[168:171], v[216:219], v[132:135], 0
    ds_write_b64 v248, v[228:229] offset:5304
    v_cvt_pk_bf16_f32 v233, v234, v235
    v_mfma_f32_16x16x32_bf16 v[180:183], v[12:15], v[132:135], v[180:183]
    ds_write_b64 v248, v[232:233] offset:8704
    v_mfma_f32_16x16x32_bf16 v[184:187], v[16:19], v[132:135], v[184:187]
    v_cvt_pk_bf16_f32 v156, v156, v157
    v_cvt_pk_bf16_f32 v157, v158, v159
    v_mfma_f32_16x16x32_bf16 v[188:191], v[20:23], v[132:135], v[188:191]
    v_cvt_pk_bf16_f32 v160, v160, v161
    v_mfma_f32_16x16x32_bf16 v[196:199], v[24:27], v[132:135], 0
    ds_read_b128 v[132:135], v252 offset:5120
    v_cvt_pk_bf16_f32 v161, v162, v163
    s_waitcnt lgkmcnt(15)
    s_nop 0
    v_mfma_f32_16x16x32_bf16 v[220:223], v[204:207], v[136:139], 0
    ds_write_b64 v248, v[156:157] offset:1224
    v_cvt_pk_bf16_f32 v164, v164, v165
    v_mfma_f32_16x16x32_bf16 v[224:227], v[208:211], v[136:139], 0
    ds_write_b64 v248, v[160:161] offset:3536
    v_cvt_pk_bf16_f32 v165, v166, v167
    v_mfma_f32_16x16x32_bf16 v[228:231], v[212:215], v[136:139], 0
    v_cvt_pk_bf16_f32 v168, v168, v169
    v_mfma_f32_16x16x32_bf16 v[232:235], v[216:219], v[136:139], 0
    ds_write_b64 v248, v[164:165] offset:5848
    v_cvt_pk_bf16_f32 v169, v170, v171
    v_mfma_f32_16x16x32_bf16 v[184:187], v[12:15], v[136:139], v[184:187]
    ds_write_b64 v248, v[168:169] offset:9248
    v_mfma_f32_16x16x32_bf16 v[188:191], v[16:19], v[136:139], v[188:191]
    v_cvt_pk_bf16_f32 v220, v220, v221
    v_cvt_pk_bf16_f32 v221, v222, v223
    v_mfma_f32_16x16x32_bf16 v[192:195], v[20:23], v[136:139], v[192:195]
    v_cvt_pk_bf16_f32 v224, v224, v225
    v_mfma_f32_16x16x32_bf16 v[200:203], v[24:27], v[136:139], 0
    ds_read_b128 v[136:139], v252 offset:7168
    v_cvt_pk_bf16_f32 v225, v226, v227
    s_waitcnt lgkmcnt(15)
    s_nop 0
    v_mfma_f32_16x16x32_bf16 v[164:167], v[212:215], v[140:143], 0
    ds_write_b64 v248, v[220:221] offset:1768
    v_cvt_pk_bf16_f32 v228, v228, v229
    v_mfma_f32_16x16x32_bf16 v[168:171], v[216:219], v[140:143], 0
    ds_write_b64 v248, v[224:225] offset:4080
    v_cvt_pk_bf16_f32 v229, v230, v231
    v_mfma_f32_16x16x32_bf16 v[188:191], v[12:15], v[140:143], v[188:191]
    v_cvt_pk_bf16_f32 v232, v232, v233
    v_mfma_f32_16x16x32_bf16 v[192:195], v[16:19], v[140:143], v[192:195]
    ds_write_b64 v248, v[228:229] offset:6392
    v_cvt_pk_bf16_f32 v233, v234, v235
    v_mfma_f32_16x16x32_bf16 v[196:199], v[20:23], v[140:143], v[196:199]
    ds_write_b64 v248, v[232:233] offset:9792
    ds_read_b128 v[140:143], v252 offset:9216
    v_mfma_f32_16x16x32_bf16 v[228:231], v[212:215], v[144:147], 0
    v_cvt_pk_bf16_f32 v164, v164, v165
    v_cvt_pk_bf16_f32 v165, v166, v167
    v_mfma_f32_16x16x32_bf16 v[232:235], v[216:219], v[144:147], 0
    v_cvt_pk_bf16_f32 v168, v168, v169
    v_mfma_f32_16x16x32_bf16 v[192:195], v[12:15], v[144:147], v[192:195]
    v_cvt_pk_bf16_f32 v169, v170, v171
    v_mfma_f32_16x16x32_bf16 v[196:199], v[16:19], v[144:147], v[196:199]
    ds_write_b64 v248, v[164:165] offset:6936
    v_mfma_f32_16x16x32_bf16 v[200:203], v[20:23], v[144:147], v[200:203]
    ds_write_b64 v248, v[168:169] offset:10336
    ds_read_b128 v[144:147], v252 offset:11264
    v_mfma_f32_16x16x32_bf16 v[196:199], v[12:15], v[148:151], v[196:199]
    v_mfma_f32_16x16x32_bf16 v[200:203], v[16:19], v[148:151], v[200:203]
    ds_read_b128 v[148:151], v252 offset:13312
    v_mfma_f32_16x16x32_bf16 v[200:203], v[12:15], v[152:155], v[200:203]
    ds_read_b128 v[152:155], v252 offset:15360
    v_mfma_f32_16x16x32_bf16 v[172:175], v[28:31], v[124:127], v[172:175]
    v_cvt_pk_bf16_f32 v228, v228, v229
    v_cvt_pk_bf16_f32 v229, v230, v231
    v_mfma_f32_16x16x32_bf16 v[176:179], v[32:35], v[124:127], v[176:179]
    ds_read_b128 v[124:127], v253 offset:1024
    v_cvt_pk_bf16_f32 v232, v232, v233
    v_cvt_pk_bf16_f32 v233, v234, v235
    s_waitcnt lgkmcnt(15)
    s_nop 0
    v_mfma_f32_16x16x32_bf16 v[176:179], v[28:31], v[128:131], v[176:179]
    ds_write_b64 v248, v[228:229] offset:7480
    v_mfma_f32_16x16x32_bf16 v[180:183], v[32:35], v[128:131], v[180:183]
    ds_read_b128 v[128:131], v253 offset:3072
    ds_write_b64 v248, v[232:233] offset:10880
    v_mfma_f32_16x16x32_bf16 v[180:183], v[28:31], v[132:135], v[180:183]
    ds_read_b64_tr_b16 v[156:157], v249 offset:4624
    v_mfma_f32_16x16x32_bf16 v[184:187], v[32:35], v[132:135], v[184:187]
    ds_read_b128 v[132:135], v253 offset:5120
    ds_read_b64_tr_b16 v[158:159], v249 offset:4760
    s_waitcnt lgkmcnt(15)
    v_mfma_f32_16x16x32_bf16 v[184:187], v[28:31], v[136:139], v[184:187]
    ds_read_b64_tr_b16 v[160:161], v249 offset:4896
    v_mfma_f32_16x16x32_bf16 v[188:191], v[32:35], v[136:139], v[188:191]
    ds_read_b128 v[136:139], v253 offset:7168
    s_waitcnt lgkmcnt(14)
    v_mfma_f32_16x16x32_bf16 v[188:191], v[28:31], v[140:143], v[188:191]
    ds_read_b64_tr_b16 v[162:163], v249 offset:5032
    v_mfma_f32_16x16x32_bf16 v[192:195], v[32:35], v[140:143], v[192:195]
    ds_read_b128 v[140:143], v253 offset:9216
    ds_read_b64_tr_b16 v[164:165], v249 offset:5168
    s_waitcnt lgkmcnt(14)
    v_mfma_f32_16x16x32_bf16 v[192:195], v[28:31], v[144:147], v[192:195]
    ds_read_b64_tr_b16 v[166:167], v249 offset:5304
    v_mfma_f32_16x16x32_bf16 v[196:199], v[32:35], v[144:147], v[196:199]
    ds_read_b128 v[144:147], v253 offset:11264
    s_waitcnt lgkmcnt(15)
    v_mfma_f32_16x16x32_bf16 v[196:199], v[28:31], v[148:151], v[196:199]
    ds_read_b64_tr_b16 v[168:169], v247 offset:0
    v_mfma_f32_16x16x32_bf16 v[200:203], v[32:35], v[148:151], v[200:203]
    ds_read_b128 v[148:151], v253 offset:13312
    ds_read_b64_tr_b16 v[170:171], v247 offset:136
    s_waitcnt lgkmcnt(15)
    s_nop 0
    v_mfma_f32_16x16x32_bf16 v[200:203], v[28:31], v[152:155], v[200:203]
    ds_read_b128 v[152:155], v253 offset:15360
    v_mfma_f32_16x16x32_bf16 v[172:175], v[36:39], v[124:127], v[172:175]
    v_mfma_f32_16x16x32_bf16 v[176:179], v[40:43], v[124:127], v[176:179]
    ds_read_b128 v[124:127], v254 offset:1024
    s_waitcnt lgkmcnt(15)
    v_mfma_f32_16x16x32_bf16 v[176:179], v[36:39], v[128:131], v[176:179]
    v_mfma_f32_16x16x32_bf16 v[180:183], v[40:43], v[128:131], v[180:183]
    ds_read_b128 v[128:131], v254 offset:3072
    s_waitcnt lgkmcnt(14)
    v_mfma_f32_16x16x32_bf16 v[180:183], v[36:39], v[132:135], v[180:183]
    ds_read_b64_tr_b16 v[220:221], v249 offset:5440
    v_mfma_f32_16x16x32_bf16 v[184:187], v[40:43], v[132:135], v[184:187]
    ds_read_b128 v[132:135], v254 offset:5120
    s_waitcnt lgkmcnt(13)
    v_mfma_f32_16x16x32_bf16 v[184:187], v[36:39], v[136:139], v[184:187]
    v_mfma_f32_16x16x32_bf16 v[188:191], v[40:43], v[136:139], v[188:191]
    ds_read_b128 v[136:139], v254 offset:7168
    ds_read_b64_tr_b16 v[222:223], v249 offset:5576
    s_waitcnt lgkmcnt(13)
    v_mfma_f32_16x16x32_bf16 v[188:191], v[36:39], v[140:143], v[188:191]
    v_mfma_f32_16x16x32_bf16 v[192:195], v[40:43], v[140:143], v[192:195]
    ds_read_b128 v[140:143], v254 offset:9216
    s_waitcnt lgkmcnt(11)
    v_mfma_f32_16x16x32_bf16 v[192:195], v[36:39], v[144:147], v[192:195]
    ds_read_b64_tr_b16 v[224:225], v249 offset:5712
    v_mfma_f32_16x16x32_bf16 v[196:199], v[40:43], v[144:147], v[196:199]
    ds_read_b128 v[144:147], v254 offset:11264
    s_waitcnt lgkmcnt(11)
    v_mfma_f32_16x16x32_bf16 v[196:199], v[36:39], v[148:151], v[196:199]
    v_mfma_f32_16x16x32_bf16 v[200:203], v[40:43], v[148:151], v[200:203]
    ds_read_b128 v[148:151], v254 offset:13312
    ds_read_b64_tr_b16 v[226:227], v249 offset:5848
    s_waitcnt lgkmcnt(11)
    s_nop 0
    v_mfma_f32_16x16x32_bf16 v[200:203], v[36:39], v[152:155], v[200:203]
    ds_read_b128 v[152:155], v254 offset:15360
    v_mfma_f32_16x16x32_bf16 v[180:183], v[156:159], v[104:107], v[180:183]
    v_mfma_f32_16x16x32_bf16 v[184:187], v[156:159], v[112:115], v[184:187]
    ds_read_b64_tr_b16 v[228:229], v249 offset:5984
    v_mfma_f32_16x16x32_bf16 v[188:191], v[156:159], v[120:123], v[188:191]
    v_mfma_f32_16x16x32_bf16 v[180:183], v[160:163], v[100:103], v[180:183]
    v_mfma_f32_16x16x32_bf16 v[184:187], v[160:163], v[108:111], v[184:187]
    ds_read_b64_tr_b16 v[230:231], v249 offset:6120
    v_mfma_f32_16x16x32_bf16 v[188:191], v[160:163], v[116:119], v[188:191]
    v_mfma_f32_16x16x32_bf16 v[184:187], v[164:167], v[104:107], v[184:187]
    v_mfma_f32_16x16x32_bf16 v[188:191], v[164:167], v[112:115], v[188:191]
    ds_read_b64_tr_b16 v[232:233], v247 offset:1632
    v_mfma_f32_16x16x32_bf16 v[192:195], v[164:167], v[120:123], v[192:195]
    v_mfma_f32_16x16x32_bf16 v[188:191], v[168:171], v[84:87], v[188:191]
    v_mfma_f32_16x16x32_bf16 v[192:195], v[168:171], v[88:91], v[192:195]
    ds_read_b64_tr_b16 v[234:235], v247 offset:1768
    v_mfma_f32_16x16x32_bf16 v[196:199], v[168:171], v[92:95], v[196:199]
    v_mfma_f32_16x16x32_bf16 v[200:203], v[168:171], v[96:99], v[200:203]
    s_waitcnt lgkmcnt(15)
    v_mfma_f32_16x16x32_bf16 v[172:175], v[44:47], v[124:127], v[172:175]
    v_mfma_f32_16x16x32_bf16 v[176:179], v[48:51], v[124:127], v[176:179]
    ds_read_b128 v[124:127], v251 offset:0
    s_waitcnt lgkmcnt(15)
    v_mfma_f32_16x16x32_bf16 v[176:179], v[44:47], v[128:131], v[176:179]
    v_mfma_f32_16x16x32_bf16 v[180:183], v[48:51], v[128:131], v[180:183]
    ds_read_b128 v[128:131], v251 offset:2048
    s_waitcnt lgkmcnt(14)
    v_mfma_f32_16x16x32_bf16 v[180:183], v[44:47], v[132:135], v[180:183]
    ds_read_b64_tr_b16 v[156:157], v249 offset:6256
    v_mfma_f32_16x16x32_bf16 v[184:187], v[48:51], v[132:135], v[184:187]
    ds_read_b128 v[132:135], v251 offset:4096
    s_waitcnt lgkmcnt(15)
    v_mfma_f32_16x16x32_bf16 v[184:187], v[44:47], v[136:139], v[184:187]
    v_mfma_f32_16x16x32_bf16 v[188:191], v[48:51], v[136:139], v[188:191]
    ds_read_b128 v[136:139], v251 offset:6144
    ds_read_b64_tr_b16 v[158:159], v249 offset:6392
    s_waitcnt lgkmcnt(15)
    v_mfma_f32_16x16x32_bf16 v[188:191], v[44:47], v[140:143], v[188:191]
    v_mfma_f32_16x16x32_bf16 v[192:195], v[48:51], v[140:143], v[192:195]
    ds_read_b128 v[140:143], v251 offset:8192
    s_waitcnt lgkmcnt(14)
    v_mfma_f32_16x16x32_bf16 v[192:195], v[44:47], v[144:147], v[192:195]
    v_mfma_f32_16x16x32_bf16 v[196:199], v[48:51], v[144:147], v[196:199]
    ds_read_b128 v[144:147], v251 offset:10240
    ds_read_b64_tr_b16 v[160:161], v249 offset:6528
    s_waitcnt lgkmcnt(15)
    v_mfma_f32_16x16x32_bf16 v[196:199], v[44:47], v[148:151], v[196:199]
    v_mfma_f32_16x16x32_bf16 v[200:203], v[48:51], v[148:151], v[200:203]
    ds_read_b128 v[148:151], v251 offset:12288
    s_waitcnt lgkmcnt(14)
    v_mfma_f32_16x16x32_bf16 v[200:203], v[44:47], v[152:155], v[200:203]
    ds_read_b128 v[152:155], v251 offset:14336
    ds_read_b64_tr_b16 v[162:163], v249 offset:6664
    v_mfma_f32_16x16x32_bf16 v[184:187], v[220:223], v[100:103], v[184:187]
    v_mfma_f32_16x16x32_bf16 v[188:191], v[220:223], v[108:111], v[188:191]
    v_mfma_f32_16x16x32_bf16 v[192:195], v[220:223], v[116:119], v[192:195]
    v_mfma_f32_16x16x32_bf16 v[188:191], v[224:227], v[104:107], v[188:191]
    ds_read_b64_tr_b16 v[164:165], v247 offset:544
    v_mfma_f32_16x16x32_bf16 v[192:195], v[224:227], v[112:115], v[192:195]
    v_mfma_f32_16x16x32_bf16 v[196:199], v[224:227], v[120:123], v[196:199]
    s_waitcnt lgkmcnt(15)
    v_mfma_f32_16x16x32_bf16 v[188:191], v[228:231], v[100:103], v[188:191]
    ds_read_b64_tr_b16 v[166:167], v247 offset:680
    v_mfma_f32_16x16x32_bf16 v[192:195], v[228:231], v[108:111], v[192:195]
    v_mfma_f32_16x16x32_bf16 v[196:199], v[228:231], v[116:119], v[196:199]
    s_waitcnt lgkmcnt(14)
    v_mfma_f32_16x16x32_bf16 v[200:203], v[232:235], v[84:87], v[200:203]
    s_waitcnt lgkmcnt(13)
    v_mfma_f32_16x16x32_bf16 v[172:175], v[52:55], v[124:127], v[172:175]
    v_mfma_f32_16x16x32_bf16 v[176:179], v[56:59], v[124:127], v[176:179]
    ds_read_b128 v[124:127], v252 offset:0
    s_waitcnt lgkmcnt(13)
    v_mfma_f32_16x16x32_bf16 v[176:179], v[52:55], v[128:131], v[176:179]
    v_mfma_f32_16x16x32_bf16 v[180:183], v[56:59], v[128:131], v[180:183]
    ds_read_b128 v[128:131], v252 offset:2048
    s_waitcnt lgkmcnt(12)
    v_mfma_f32_16x16x32_bf16 v[180:183], v[52:55], v[132:135], v[180:183]
    ds_read_b64_tr_b16 v[220:221], v249 offset:6800
    v_mfma_f32_16x16x32_bf16 v[184:187], v[56:59], v[132:135], v[184:187]
    ds_read_b128 v[132:135], v252 offset:4096
    s_waitcnt lgkmcnt(13)
    v_mfma_f32_16x16x32_bf16 v[184:187], v[52:55], v[136:139], v[184:187]
    v_mfma_f32_16x16x32_bf16 v[188:191], v[56:59], v[136:139], v[188:191]
    ds_read_b128 v[136:139], v252 offset:6144
    ds_read_b64_tr_b16 v[222:223], v249 offset:6936
    s_waitcnt lgkmcnt(13)
    v_mfma_f32_16x16x32_bf16 v[188:191], v[52:55], v[140:143], v[188:191]
    v_mfma_f32_16x16x32_bf16 v[192:195], v[56:59], v[140:143], v[192:195]
    ds_read_b128 v[140:143], v252 offset:8192
    s_waitcnt lgkmcnt(13)
    v_mfma_f32_16x16x32_bf16 v[192:195], v[52:55], v[144:147], v[192:195]
    ds_read_b64_tr_b16 v[224:225], v249 offset:7072
    v_mfma_f32_16x16x32_bf16 v[196:199], v[56:59], v[144:147], v[196:199]
    ds_read_b128 v[144:147], v252 offset:10240
    s_waitcnt lgkmcnt(13)
    v_mfma_f32_16x16x32_bf16 v[196:199], v[52:55], v[148:151], v[196:199]
    v_mfma_f32_16x16x32_bf16 v[200:203], v[56:59], v[148:151], v[200:203]
    ds_read_b128 v[148:151], v252 offset:12288
    s_waitcnt lgkmcnt(13)
    v_mfma_f32_16x16x32_bf16 v[200:203], v[52:55], v[152:155], v[200:203]
    ds_read_b128 v[152:155], v252 offset:14336
    ds_read_b64_tr_b16 v[226:227], v249 offset:7208
    v_mfma_f32_16x16x32_bf16 v[192:195], v[156:159], v[104:107], v[192:195]
    v_mfma_f32_16x16x32_bf16 v[196:199], v[156:159], v[112:115], v[196:199]
    v_mfma_f32_16x16x32_bf16 v[200:203], v[156:159], v[120:123], v[200:203]
    ds_read_b64_tr_b16 v[228:229], v247 offset:1088
    s_waitcnt lgkmcnt(15)
    v_mfma_f32_16x16x32_bf16 v[192:195], v[160:163], v[100:103], v[192:195]
    v_mfma_f32_16x16x32_bf16 v[196:199], v[160:163], v[108:111], v[196:199]
    v_mfma_f32_16x16x32_bf16 v[200:203], v[160:163], v[116:119], v[200:203]
    ds_read_b64_tr_b16 v[230:231], v247 offset:1224
    s_waitcnt lgkmcnt(14)
    v_mfma_f32_16x16x32_bf16 v[192:195], v[164:167], v[84:87], v[192:195]
    v_mfma_f32_16x16x32_bf16 v[196:199], v[164:167], v[88:91], v[196:199]
    v_mfma_f32_16x16x32_bf16 v[200:203], v[164:167], v[92:95], v[200:203]
    s_waitcnt lgkmcnt(13)
    v_mfma_f32_16x16x32_bf16 v[172:175], v[60:63], v[124:127], v[172:175]
    v_mfma_f32_16x16x32_bf16 v[176:179], v[64:67], v[124:127], v[176:179]
    ds_read_b128 v[124:127], v253 offset:0
    s_waitcnt lgkmcnt(13)
    v_mfma_f32_16x16x32_bf16 v[176:179], v[60:63], v[128:131], v[176:179]
    v_mfma_f32_16x16x32_bf16 v[180:183], v[64:67], v[128:131], v[180:183]
    ds_read_b128 v[128:131], v253 offset:2048
    s_waitcnt lgkmcnt(12)
    v_mfma_f32_16x16x32_bf16 v[180:183], v[60:63], v[132:135], v[180:183]
    ds_read_b64_tr_b16 v[156:157], v249 offset:7344
    v_mfma_f32_16x16x32_bf16 v[184:187], v[64:67], v[132:135], v[184:187]
    ds_read_b128 v[132:135], v253 offset:4096
    s_waitcnt lgkmcnt(13)
    v_mfma_f32_16x16x32_bf16 v[184:187], v[60:63], v[136:139], v[184:187]
    v_mfma_f32_16x16x32_bf16 v[188:191], v[64:67], v[136:139], v[188:191]
    ds_read_b128 v[136:139], v253 offset:6144
    s_waitcnt lgkmcnt(12)
    v_mfma_f32_16x16x32_bf16 v[188:191], v[60:63], v[140:143], v[188:191]
    ds_read_b64_tr_b16 v[158:159], v249 offset:7480
    v_mfma_f32_16x16x32_bf16 v[192:195], v[64:67], v[140:143], v[192:195]
    ds_read_b128 v[140:143], v253 offset:8192
    s_waitcnt lgkmcnt(12)
    v_mfma_f32_16x16x32_bf16 v[192:195], v[60:63], v[144:147], v[192:195]
    v_mfma_f32_16x16x32_bf16 v[196:199], v[64:67], v[144:147], v[196:199]
    ds_read_b128 v[144:147], v253 offset:10240
    s_waitcnt lgkmcnt(12)
    v_mfma_f32_16x16x32_bf16 v[196:199], v[60:63], v[148:151], v[196:199]
    ds_read_b64_tr_b16 v[160:161], v249 offset:7616
    v_mfma_f32_16x16x32_bf16 v[200:203], v[64:67], v[148:151], v[200:203]
    ds_read_b128 v[148:151], v253 offset:12288
    s_waitcnt lgkmcnt(13)
    v_mfma_f32_16x16x32_bf16 v[200:203], v[60:63], v[152:155], v[200:203]
    ds_read_b128 v[152:155], v253 offset:14336
    v_mfma_f32_16x16x32_bf16 v[196:199], v[220:223], v[104:107], v[196:199]
    v_mfma_f32_16x16x32_bf16 v[200:203], v[220:223], v[112:115], v[200:203]
    ds_read_b64_tr_b16 v[162:163], v249 offset:7752
    s_waitcnt lgkmcnt(14)
    v_mfma_f32_16x16x32_bf16 v[196:199], v[224:227], v[100:103], v[196:199]
    v_mfma_f32_16x16x32_bf16 v[200:203], v[224:227], v[108:111], v[200:203]
    s_waitcnt lgkmcnt(12)
    v_mfma_f32_16x16x32_bf16 v[196:199], v[228:231], v[84:87], v[196:199]
    v_mfma_f32_16x16x32_bf16 v[200:203], v[228:231], v[88:91], v[200:203]
    s_waitcnt lgkmcnt(11)
    v_mfma_f32_16x16x32_bf16 v[172:175], v[68:71], v[124:127], v[172:175]
    v_mfma_f32_16x16x32_bf16 v[176:179], v[72:75], v[124:127], v[176:179]
    ds_read_b128 v[124:127], v254 offset:0
    s_waitcnt lgkmcnt(11)
    v_mfma_f32_16x16x32_bf16 v[176:179], v[68:71], v[128:131], v[176:179]
    v_mfma_f32_16x16x32_bf16 v[180:183], v[72:75], v[128:131], v[180:183]
    ds_read_b128 v[128:131], v254 offset:2048
    s_waitcnt lgkmcnt(10)
    v_mfma_f32_16x16x32_bf16 v[180:183], v[68:71], v[132:135], v[180:183]
    v_mfma_f32_16x16x32_bf16 v[184:187], v[72:75], v[132:135], v[184:187]
    ds_read_b128 v[132:135], v254 offset:4096
    s_waitcnt lgkmcnt(10)
    v_mfma_f32_16x16x32_bf16 v[184:187], v[68:71], v[136:139], v[184:187]
    v_mfma_f32_16x16x32_bf16 v[188:191], v[72:75], v[136:139], v[188:191]
    ds_read_b128 v[136:139], v254 offset:6144
    s_waitcnt lgkmcnt(9)
    v_mfma_f32_16x16x32_bf16 v[188:191], v[68:71], v[140:143], v[188:191]
    v_mfma_f32_16x16x32_bf16 v[192:195], v[72:75], v[140:143], v[192:195]
    ds_read_b128 v[140:143], v254 offset:8192
    s_waitcnt lgkmcnt(9)
    v_mfma_f32_16x16x32_bf16 v[192:195], v[68:71], v[144:147], v[192:195]
    v_mfma_f32_16x16x32_bf16 v[196:199], v[72:75], v[144:147], v[196:199]
    ds_read_b128 v[144:147], v254 offset:10240
    s_waitcnt lgkmcnt(8)
    v_mfma_f32_16x16x32_bf16 v[196:199], v[68:71], v[148:151], v[196:199]
    v_mfma_f32_16x16x32_bf16 v[200:203], v[72:75], v[148:151], v[200:203]
    ds_read_b128 v[148:151], v254 offset:12288
    s_waitcnt lgkmcnt(8)
    v_mfma_f32_16x16x32_bf16 v[200:203], v[68:71], v[152:155], v[200:203]
    ds_read_b128 v[152:155], v254 offset:14336
    v_mfma_f32_16x16x32_bf16 v[200:203], v[156:159], v[104:107], v[200:203]
    s_waitcnt lgkmcnt(8)
    v_mfma_f32_16x16x32_bf16 v[200:203], v[160:163], v[100:103], v[200:203]
    s_waitcnt lgkmcnt(7)
    v_mfma_f32_16x16x32_bf16 v[172:175], v[76:79], v[124:127], v[172:175]
    v_mfma_f32_16x16x32_bf16 v[176:179], v[80:83], v[124:127], v[176:179]
    s_waitcnt lgkmcnt(6)
    v_mfma_f32_16x16x32_bf16 v[176:179], v[76:79], v[128:131], v[176:179]
    v_mfma_f32_16x16x32_bf16 v[180:183], v[80:83], v[128:131], v[180:183]
    s_waitcnt lgkmcnt(5)
    v_mfma_f32_16x16x32_bf16 v[180:183], v[76:79], v[132:135], v[180:183]
    v_mfma_f32_16x16x32_bf16 v[184:187], v[80:83], v[132:135], v[184:187]
    s_nop 0
    v_cvt_pk_bf16_f32 v12, v172, v173
    s_waitcnt lgkmcnt(4)
    v_mfma_f32_16x16x32_bf16 v[184:187], v[76:79], v[136:139], v[184:187]
    v_cvt_pk_bf16_f32 v13, v174, v175
    v_mfma_f32_16x16x32_bf16 v[188:191], v[80:83], v[136:139], v[188:191]
    v_cvt_pk_bf16_f32 v14, v176, v177
    s_waitcnt lgkmcnt(3)
    s_nop 0
    v_mfma_f32_16x16x32_bf16 v[188:191], v[76:79], v[140:143], v[188:191]
    ds_write_b64 v4, v[12:13] offset:6144
    v_cvt_pk_bf16_f32 v15, v178, v179
    v_mfma_f32_16x16x32_bf16 v[192:195], v[80:83], v[140:143], v[192:195]
    v_cvt_pk_bf16_f32 v16, v180, v181
    s_waitcnt lgkmcnt(3)
    s_nop 0
    v_mfma_f32_16x16x32_bf16 v[192:195], v[76:79], v[144:147], v[192:195]
    ds_write_b64 v4, v[14:15] offset:6688
    v_cvt_pk_bf16_f32 v17, v182, v183
    v_mfma_f32_16x16x32_bf16 v[196:199], v[80:83], v[144:147], v[196:199]
    v_cvt_pk_bf16_f32 v18, v184, v185
    s_waitcnt lgkmcnt(3)
    v_mfma_f32_16x16x32_bf16 v[196:199], v[76:79], v[148:151], v[196:199]
    ds_write_b64 v4, v[16:17] offset:7232
    v_cvt_pk_bf16_f32 v19, v186, v187
    v_mfma_f32_16x16x32_bf16 v[200:203], v[80:83], v[148:151], v[200:203]
    s_waitcnt lgkmcnt(3)
    v_mfma_f32_16x16x32_bf16 v[200:203], v[76:79], v[152:155], v[200:203]
    ds_write_b64 v4, v[18:19] offset:7776
    v_cvt_pk_bf16_f32 v20, v188, v189
    v_cvt_pk_bf16_f32 v21, v190, v191
    v_cvt_pk_bf16_f32 v22, v192, v193
    v_cvt_pk_bf16_f32 v23, v194, v195
    v_cvt_pk_bf16_f32 v24, v196, v197
    v_cvt_pk_bf16_f32 v25, v198, v199
    s_nop 0
    s_nop 0
    v_cvt_pk_bf16_f32 v26, v200, v201
    v_cvt_pk_bf16_f32 v27, v202, v203
    ds_write_b64 v4, v[20:21] offset:8320
    ds_write_b64 v4, v[22:23] offset:8864
    ds_write_b64 v4, v[24:25] offset:9408
    ds_write_b64 v4, v[26:27] offset:9952
    s_waitcnt lgkmcnt(0)
    s_barrier
    s_setprio 3
    s_nop 0
    ds_read_b64_tr_b16 v[44:45], v5 offset:0
    ds_read_b64_tr_b16 v[46:47], v5 offset:16
    ds_read_b64_tr_b16 v[48:49], v5 offset:272
    ds_read_b64_tr_b16 v[50:51], v5 offset:288
    ds_read_b64_tr_b16 v[52:53], v5 offset:544
    ds_read_b64_tr_b16 v[54:55], v5 offset:560
    ds_read_b64_tr_b16 v[56:57], v5 offset:816
    ds_read_b64_tr_b16 v[58:59], v5 offset:832
    s_waitcnt lgkmcnt(6)
    buffer_store_dwordx4 v[44:47], v246, s[48:51], s71 offen offset:0 sc1
    s_waitcnt lgkmcnt(4)
    buffer_store_dwordx4 v[48:51], v246, s[48:51], s71 offen offset:1024 sc1
    s_waitcnt lgkmcnt(2)
    buffer_store_dwordx4 v[52:55], v246, s[48:51], s71 offen offset:2048 sc1
    s_waitcnt lgkmcnt(0)
    buffer_store_dwordx4 v[56:59], v246, s[48:51], s71 offen offset:3072 sc1
    v_lshrrev_b32 v8, 3, v1
    v_lshlrev_b32 v8, 14, v8
    v_and_b32 v9, 7, v1
    v_xor_b32 v9, v9, v2
    v_lshl_add_u32 v4, v9, 4, v8
    s_and_b32 s4, s76, 1
    s_lshl_b32 s4, s4, 6
    v_xor_b32_e64 v4, s4, v4
    s_mul_i32 s4, s76, 130944
    s_add_u32 s72, s72, s4
    s_lshl_b32 s4, s76, 12
    s_add_u32 s68, s68, s4
    s_lshl_b32 s6, s76, 10
    v_and_b32 v8, 7, v3
    v_xor_b32 v8, v8, v2
    v_lshlrev_b32_e64 v6, 8, v3
    v_lshl_add_u32 v6, v8, 4, v6
    v_add_u32_e64 v6, s64, v6
    v_mul_u32_u24 v7, 2560, v2
    v_lshl_add_u32 v7, v3, 4, v7
    v_xor_b32 v8, 64, v6
    s_waitcnt vmcnt(0)
    s_mov_b64 exec, 0xff
    buffer_store_dword v255, v250, s[48:51], s68 offen sc1
    s_mov_b64 exec, -1
    s_waitcnt lgkmcnt(0)
    s_mov_b32 s13, 0
L_ssp_29:
    s_buffer_load_dwordx8 s[16:23], s[48:51], s69 glc
    s_add_u32 s13, s13, 1
    s_waitcnt lgkmcnt(0)
    s_cmp_gt_u32 s13, 30000
    s_cbranch_scc1 L_sok_28
    s_mov_b32 s14, s83
    s_mov_b32 s15, s83
    s_xor_b64 s[8:9], s[16:17], s[14:15]
    s_xor_b64 s[16:17], s[18:19], s[14:15]
    s_or_b64 s[8:9], s[8:9], s[16:17]
    s_xor_b64 s[16:17], s[20:21], s[14:15]
    s_or_b64 s[8:9], s[8:9], s[16:17]
    s_xor_b64 s[16:17], s[22:23], s[14:15]
    s_or_b64 s[8:9], s[8:9], s[16:17]
    s_cbranch_scc0 L_sok_28
    s_sleep 2
    s_branch L_ssp_29
L_sok_28:
    s_add_u32 m0, s6, 2048
    s_add_u32 s5, s72, 0
    s_nop 0
    buffer_load_dwordx4 v4, s[48:51], s5 offen sc1 lds
    s_add_u32 m0, s6, 6144
    s_add_u32 s5, s72, 128
    buffer_load_dwordx4 v4, s[48:51], s5 offen sc1 lds
    s_add_u32 m0, s6, 10240
    s_add_u32 s5, s72, 256
    buffer_load_dwordx4 v4, s[48:51], s5 offen sc1 lds
    s_add_u32 m0, s6, 14336
    s_add_u32 s5, s72, 384
    buffer_load_dwordx4 v4, s[48:51], s5 offen sc1 lds
    s_waitcnt vmcnt(0)
    s_barrier
    ds_read2_b64 v[12:15], v6 offset0:0 offset1:16
    ds_read2_b64 v[16:19], v8 offset0:0 offset1:16
    ds_read2_b64 v[20:23], v6 offset0:1 offset1:17
    ds_read2_b64 v[24:27], v8 offset0:1 offset1:17
    s_add_u32 s5, s73, 0
    s_waitcnt lgkmcnt(3)
    buffer_store_dwordx4 v[12:15], v7, s[52:55], s5 offen sc1
    s_add_u32 s5, s73, 10240
    s_waitcnt lgkmcnt(2)
    buffer_store_dwordx4 v[16:19], v7, s[52:55], s5 offen sc1
    s_add_u32 s5, s73, 20480
    s_waitcnt lgkmcnt(1)
    buffer_store_dwordx4 v[20:23], v7, s[52:55], s5 offen sc1
    s_add_u32 s5, s73, 30720
    s_waitcnt lgkmcnt(0)
    buffer_store_dwordx4 v[24:27], v7, s[52:55], s5 offen sc1
    s_endpgm
L_notA:
    s_cmp_lt_u32 s2, 496
    s_cbranch_scc1 L_goC
    s_endpgm
L_goC:
    v_and_b32 v1, 63, v0
    v_lshrrev_b32 v6, 6, v0
    s_sub_u32 s77, s2, 416
    v_readfirstlane_b32 s76, v6
    v_mul_u32_u24 v7, 3277, v1
    v_lshrrev_b32 v7, 16, v7
    v_mul_u32_u24 v7, 960, v7
    v_lshl_add_u32 v2, v1, 4, v7
    v_add_u32_e64 v6, 64, v1
    v_mul_u32_u24 v7, 3277, v6
    v_lshrrev_b32_e64 v7, 16, v7
    v_mul_u32_u24 v7, 960, v7
    v_lshl_add_u32 v3, v1, 4, v7
    v_add_u32 v6, 128, v1
    v_mul_u32_u24 v7, 3277, v6
    v_lshrrev_b32_e64 v7, 16, v7
    v_mul_u32_u24 v7, 960, v7
    v_lshl_add_u32 v4, v1, 4, v7
    s_mul_i32 s4, s77, 10240
    s_mul_i32 s5, s76, 320
    s_add_u32 s4, s4, s5
    s_lshl_b32 s6, s76, 12
    s_mov_b32 m0, s6
    s_waitcnt lgkmcnt(0)
    s_mov_b32 s68, s22
    s_nop 0
    s_and_b32 s69, s23, 0xffff
    s_mov_b32 s70, 819200
    s_mov_b32 s71, 0x00020000
    buffer_load_dwordx4 v2, s[68:71], s4 offen offset:0 lds
    buffer_load_dwordx4 v3, s[68:71], s4 offen offset:1024 lds
    s_mov_b32 exec_hi, 0
    buffer_load_dwordx4 v4, s[68:71], s4 offen offset:2048 lds
    s_mov_b64 exec, -1
    s_mov_b32 s48, s46
    s_and_b32 s49, s47, 0xffff
    s_mov_b32 s50, 16777216
    s_mov_b32 s51, 0x00020000
    s_mov_b32 s56, s44
    s_and_b32 s57, s45, 0xffff
    s_mov_b32 s58, 256
    s_mov_b32 s59, 0x00020000
    v_lshrrev_b32 v6, 4, v1
    v_add_u32 v6, 0, v6
    v_min_u32 v6, 9, v6
    v_cmp_lt_u32 vcc, 4, v6
    v_lshlrev_b32_e64 v8, 3, v6
    v_add_u32 v7, 120, v8
    v_cndmask_b32 v8, v8, v7, vcc
    v_lshlrev_b32 v11, 10, v6
    v_add_u32 v7, 97280, v11
    v_cndmask_b32 v11, v11, v7, vcc
    v_and_b32 v6, 3, v1
    v_mul_u32_u24_e64 v6, 40, v6
    v_bfe_u32 v7, v1, 2, 2
    v_mul_u32_u24 v7, 320, v7
    v_add3_u32 v8, v8, v6, v7
    v_add_u32 v8, s6, v8
    v_and_b32 v6, 15, v1
    v_lshl_add_u32 v11, v6, 4, v11
    v_lshrrev_b32 v6, 4, v1
    v_add_u32 v6, 4, v6
    v_min_u32 v6, 9, v6
    v_cmp_lt_u32 vcc, 4, v6
    v_lshlrev_b32_e64 v9, 3, v6
    v_add_u32 v7, 120, v9
    v_cndmask_b32 v9, v9, v7, vcc
    v_lshlrev_b32 v12, 10, v6
    v_add_u32 v7, 97280, v12
    v_cndmask_b32 v12, v12, v7, vcc
    v_and_b32 v6, 3, v1
    v_mul_u32_u24_e64 v6, 40, v6
    v_bfe_u32 v7, v1, 2, 2
    v_mul_u32_u24 v7, 320, v7
    v_add3_u32 v9, v9, v6, v7
    v_add_u32 v9, s6, v9
    v_and_b32 v6, 15, v1
    v_lshl_add_u32 v12, v6, 4, v12
    v_lshrrev_b32 v6, 4, v1
    v_add_u32 v6, 8, v6
    v_min_u32 v6, 9, v6
    v_cmp_lt_u32 vcc, 4, v6
    v_lshlrev_b32_e64 v10, 3, v6
    v_add_u32 v7, 120, v10
    v_cndmask_b32 v10, v10, v7, vcc
    v_lshlrev_b32 v13, 10, v6
    v_add_u32 v7, 97280, v13
    v_cndmask_b32 v13, v13, v7, vcc
    v_and_b32 v6, 3, v1
    v_mul_u32_u24_e64 v6, 40, v6
    v_bfe_u32 v7, v1, 2, 2
    v_mul_u32_u24 v7, 320, v7
    v_add3_u32 v10, v10, v6, v7
    v_add_u32 v10, s6, v10
    v_and_b32 v6, 15, v1
    v_lshl_add_u32 v13, v6, 4, v13
    s_mul_i32 s4, s76, 204800
    s_lshr_b32 s5, s77, 2
    s_mul_i32 s5, s5, 5120
    s_add_u32 s4, s4, s5
    s_and_b32 s5, s77, 3
    s_lshl_b32 s5, s5, 8
    s_add_u32 s4, s4, s5
    s_add_u32 s4, s4, 7864320
    s_lshr_b32 s7, s77, 3
    s_lshl_b32 s7, s7, 7
    s_and_b32 s5, s77, 7
    s_lshl_b32 s5, s5, 2
    s_add_u32 s7, s7, s5
    s_add_u32 s7, s7, 10289152
    s_waitcnt vmcnt(0)
    s_nop 0
    ds_read_b64_tr_b16 v[16:17], v8 offset:0
    ds_read_b64_tr_b16 v[18:19], v8 offset:1280
    ds_read_b64_tr_b16 v[20:21], v9 offset:0
    ds_read_b64_tr_b16 v[22:23], v9 offset:1280
    ds_read_b64_tr_b16 v[24:25], v10 offset:0
    ds_read_b64_tr_b16 v[26:27], v10 offset:1280
    s_waitcnt lgkmcnt(4)
    buffer_store_dwordx4 v[16:19], v11, s[48:51], s4 offen sc1
    s_waitcnt lgkmcnt(2)
    buffer_store_dwordx4 v[20:23], v12, s[48:51], s4 offen sc1
    s_waitcnt lgkmcnt(0)
    s_mov_b32 exec_hi, 0
    buffer_store_dwordx4 v[24:27], v13, s[48:51], s4 offen sc1
    s_mov_b64 exec, -1
    buffer_load_dword v14, off, s[56:59], 0 offset:4 sc1
    s_waitcnt vmcnt(0)
    v_cmp_eq_u32_e64 vcc, 0, v14
    s_cbranch_vccz L_ok_30
    s_mov_b32 s13, 0
L_spin_31:
    buffer_load_dword v14, off, s[56:59], 0 offset:4 sc1
    s_add_u32 s13, s13, 1
    s_cmp_gt_u32 s13, 30000
    s_cbranch_scc1 L_ok_30
    s_waitcnt vmcnt(0)
    v_cmp_eq_u32_e64 vcc, 0, v14
    s_cbranch_vccnz L_spin_31
L_ok_30:
    v_readfirstlane_b32 s83, v14
    s_waitcnt vmcnt(0)
    s_barrier
    s_cmp_lg_u32 s76, 0
    s_cbranch_scc1 L_nofl_32
    s_mov_b64 exec, 1
    buffer_store_dword v14, off, s[48:51], s7 sc1
    s_mov_b64 exec, -1
L_nofl_32:
    s_endpgm
L_code_end:
.section .rodata,"a"
.p2align 6
.amdhsa_kernel concat_heads__linear_kernel_hedgehog__ssm_conv_s4__prompt_kernel
  .amdhsa_next_free_vgpr 256
  .amdhsa_next_free_sgpr 102
  .amdhsa_accum_offset 256
  .amdhsa_group_segment_fixed_size 0
  .amdhsa_kernarg_size 128
  .amdhsa_user_sgpr_count 2
  .amdhsa_user_sgpr_kernarg_segment_ptr 1
  .amdhsa_system_sgpr_workgroup_id_x 1
.end_amdhsa_kernel
```
